```python
import torch

def _softmax(x, axis=-1):
    return torch.softmax(x, dim=axis)
def _gelu(x):
    return torch.nn.functional.gelu(x, approximate="tanh")
def _silu(x):
    return torch.nn.functional.silu(x)
def _sigmoid(x):
    return torch.sigmoid(x)
def _layernorm(x, axis=-1, eps=1e-5):
    m = x.mean(dim=axis, keepdim=True)
    v = x.var(dim=axis, keepdim=True, unbiased=False)
    return (x - m) / torch.sqrt(v + eps)
def _scatter_add(tgt, idx, src, axis=0):
    return tgt.clone().index_add_(axis, idx, src)
def _segment_sum(src, seg, n):
    out = torch.zeros((n,) + src.shape[1:], dtype=src.dtype)
    return out.index_add_(0, seg, src)
def _pad(x, pw):
    flat = tuple(v for pair in reversed(pw) for v in pair)
    return torch.nn.functional.pad(x, flat)

kernel_name = 'sequential_preLN__sliding_local_dilated__swiglu_ffn__prompt'

def setup_inputs():

    _w = (lambda a: (lambda t: t.to(torch.bfloat16) if t.is_floating_point() else t)(torch.as_tensor(a)))
    def _A_setup():
        B, S, D = 1, 2048, 512
        return {
            "x": _w((lambda *s: torch.randn(*s, dtype=torch.bfloat16) * 0.05)(B, S, D)),
            "wqkv": _w((lambda *s: torch.randn(*s, dtype=torch.bfloat16) * 0.05)(D, 3 * D)),
            "wo": _w((lambda *s: torch.randn(*s, dtype=torch.bfloat16) * 0.05)(D, D)),
        }
    _A_in = _A_setup()

    def _B_setup():
        B, S, D, F = 1, 2048, 512, 1792
        return {
            "x": _w((lambda *s: torch.randn(*s, dtype=torch.bfloat16) * 0.05)(B, S, D)),
            "w_gate": _w((lambda *s: torch.randn(*s, dtype=torch.bfloat16) * 0.05)(D, F)),
            "w_up": _w((lambda *s: torch.randn(*s, dtype=torch.bfloat16) * 0.05)(D, F)),
            "w_down": _w((lambda *s: torch.randn(*s, dtype=torch.bfloat16) * 0.05)(F, D)),
        }
    _B_in = _B_setup()

    return {
        "A_x": _A_in["x"],
        "A_wqkv": _A_in["wqkv"],
        "A_wo": _A_in["wo"],
        "B_x": _B_in["x"],
        "B_w_gate": _B_in["w_gate"],
        "B_w_up": _B_in["w_up"],
        "B_w_down": _B_in["w_down"],
    }

def reference(A_x, A_wqkv, A_wo, B_x, B_w_gate, B_w_up, B_w_down):
    def _A_ref(x, wqkv, wo):
        B, S, D = x.shape
        H = 32; Dh = D // H
        W, dil = 8, 2
        qkv = (lambda x, *d: x.permute(*d))((x @ wqkv).reshape(B, S, 3, H, Dh), 2, 0, 3, 1, 4)
        q, k, v = qkv[0], qkv[1], qkv[2]
        scale = Dh ** -0.5
        pos = torch.arange(S)
        off = torch.arange(W) * dil
        idx = pos[:, None] - off[None, :]
        mask = idx >= 0
        idx_c = torch.where(mask, idx, 0).reshape(-1)
        kg = k[:, :, idx_c, :].reshape(B, H, S, W, Dh)
        vg = v[:, :, idx_c, :].reshape(B, H, S, W, Dh)
        logits = torch.einsum("bhsd,bhswd->bhsw", q, kg) * scale
        logits = torch.where(mask[None, None, :, :], logits, -1e9)
        attn = _softmax(logits, axis=-1)
        o = torch.einsum("bhsw,bhswd->bhsd", attn, vg)
        return (lambda x, *d: x.permute(*d))(o, 0, 2, 1, 3).reshape(B, S, D) @ wo

    def _B_ref(x, w_gate, w_up, w_down):
        g = _silu(x @ w_gate)
        u = x @ w_up
        return (g * u) @ w_down

    x = A_x
    h = x + _A_ref(_layernorm(x, axis=-1), A_wqkv, A_wo)
    h2 = h + _B_ref(_layernorm(h, axis=-1), B_w_gate, B_w_up, B_w_down)
    return h2
```

```asm
; @launch grid=(256,1,1) block=(512,1,1) lds=163840
.amdgcn_target "amdgcn-amd-amdhsa--gfx950"
.text
.globl sequential_preLN__sliding_local_dilated__swiglu_ffn__prompt_kernel
.p2align 8
.type sequential_preLN__sliding_local_dilated__swiglu_ffn__prompt_kernel,@function
sequential_preLN__sliding_local_dilated__swiglu_ffn__prompt_kernel:
  s_cmp_ge_u32 s2, 256
  s_cbranch_scc1 L_end
  s_load_dwordx16 s[4:19], s[0:1], 0
  s_load_dwordx4 s[20:23], s[0:1], 64
  v_and_b32 v1, 63, v0
  v_lshrrev_b32 v4, 6, v0
  v_and_b32 v2, 15, v0
  v_readfirstlane_b32 s97, v4
  v_lshrrev_b32 v3, 4, v1
  s_lshr_b32 s64, s2, 3
  s_and_b32 s61, s2, 1
  s_and_b32 s60, s64, 7
  s_lshl_b32 s57, s61, 3
  s_add_u32 s57, s57, s60
  s_and_b32 s56, s2, 6
  s_lshl_b32 s56, s56, 1
  s_lshr_b32 s63, s2, 6
  s_add_u32 s56, s56, s63
  s_and_b32 s100, s2, 4
  s_lshl_b32 s100, s100, 1
  s_lshr_b32 s63, s2, 5
  s_add_u32 s100, s100, s63
  s_and_b32 s101, s2, 3
  s_lshl_b32 s101, s101, 2
  s_and_b32 s63, s64, 3
  s_add_u32 s101, s101, s63
  s_and_b32 s58, s97, 3
  s_cmp_ge_u32 s97, 4
  s_cbranch_scc1 L_loader
  s_lshr_b32 s63, s2, 3
  s_lshl_b32 s63, s63, 1
  s_and_b32 s64, s58, 1
  s_add_u32 s63, s63, s64
  s_min_u32 s64, s63, 32
  s_lshl_b32 s64, s64, 4
  s_and_b32 s65, s56, 12
  s_lshl_b32 s65, s65, 7
  s_add_u32 s64, s64, s65
  s_sub_u32 s64, s64, 16
  v_lshrrev_b32 v4, 2, v1
  v_add_u32 v4, s64, v4
  v_max_i32 v4, 0, v4
  v_and_b32 v5, 3, v1
  v_min_u32 v5, 2, v5
  v_lshl_add_u32 v4, v4, 3, v5
  v_lshlrev_b32 v4, 7, v4
  v_add_u32 v4, 256, v4
  v_min_u32 v5, 11, v2
  v_lshrrev_b32 v6, 2, v5
  v_and_b32 v5, 3, v5
  v_lshlrev_b32 v5, 7, v5
  v_lshl_add_u32 v5, v6, 10, v5
  v_mul_u32_u24 v6, 3072, v3
  s_min_u32 s63, s63, 47
  s_add_u32 s63, s63, 32
  s_mul_i32 s64, s63, 12288
  s_lshl_b32 s65, s61, 9
  s_add_u32 s64, s64, s65
  v_add3_u32 v5, v5, v6, s64
  s_cmp_lt_u32 s58, 2
  s_cselect_b64 vcc, -1, 0
  s_movk_i32 s72, 384
  s_cselect_b32 s72, 589824, s72
  v_cndmask_b32 v30, v4, v5, vcc
  s_cmp_eq_u32 s58, 3
  s_movk_i32 s65, 28672
  s_cselect_b32 s65, 8192, s65
  v_mul_u32_u24 v28, s65, v1
  v_mul_u32_u24 v29, 51200, v0
  s_waitcnt lgkmcnt(0)
  s_cmp_lt_u32 s58, 2
  s_cselect_b32 s24, s6, s4
  s_cselect_b32 s25, s7, s5
  s_mov_b32 s26, 2097152
  s_cselect_b32 s26, 1572864, s26
  s_and_b32 s25, s25, 0xffff
  s_mov_b32 s27, 0x20000
  v_mov_b32 v40, 0x3f803f80
  v_mov_b32 v41, v40
  v_mov_b32 v42, v40
  v_mov_b32 v43, v40
  v_accvgpr_write_b32 a16, v40
  v_accvgpr_write_b32 a17, v40
  v_accvgpr_write_b32 a18, v40
  v_accvgpr_write_b32 a19, v40
  v_accvgpr_write_b32 a20, v40
  v_accvgpr_write_b32 a21, v40
  v_accvgpr_write_b32 a22, v40
  v_accvgpr_write_b32 a23, v40
  v_accvgpr_write_b32 a40, v40
  v_accvgpr_write_b32 a41, v40
  v_accvgpr_write_b32 a42, v40
  v_accvgpr_write_b32 a43, v40
  v_accvgpr_write_b32 a44, v40
  v_accvgpr_write_b32 a45, v40
  v_accvgpr_write_b32 a46, v40
  v_accvgpr_write_b32 a47, v40
  s_mov_b32 s69, 0xffff0000
  s_mov_b32 s82, 0x00010001
  s_mov_b32 s83, 0x00010001
  s_mov_b32 s84, 0xfffefffe
  s_mov_b32 s85, 0xfffefffe
  v_lshlrev_b32 v9, 4, v1
  s_lshl_b32 s62, s56, 3
  s_lshl_b32 s63, s61, 2
  s_add_u32 s62, s62, s63
  s_add_u32 s62, s62, s58
  v_lshrrev_b32 v4, 2, v2
  v_and_b32 v5, 1, v3
  v_lshl_add_u32 v4, v5, 3, v4
  v_lshlrev_b32 v4, 6, v4
  v_lshl_add_u32 v4, v5, 5, v4
  v_lshrrev_b32 v5, 1, v3
  v_mul_u32_u24 v5, 3072, v5
  v_and_b32 v6, 3, v2
  v_lshl_add_u32 v4, v6, 3, v4
  v_add_u32 v10, v4, v5
  v_xor_b32 v11, 32, v10
  v_add_u32 v12, 61440, v10
  v_add_u32 v13, 61440, v11
  s_and_b32 s63, s58, 1
  s_lshl_b32 s63, s63, 5
  s_lshr_b32 s64, s58, 1
  s_add_u32 s65, s64, 1
  s_lshl_b32 s65, s65, 10
  s_mul_i32 s64, s64, 6144
  v_xor_b32 v4, s63, v10
  v_add_u32 v14, s65, v4
  v_add_u32 v15, 61440, v14
  v_add_u32 v16, s64, v4
  v_add_u32 v44, 61440, v16
  v_and_b32 v4, 3, v2
  v_cmp_eq_u32 s[74:75], 1, v4
  v_cmp_eq_u32 s[76:77], 2, v4
  v_cmp_eq_u32 s[78:79], 3, v4
  v_lshrrev_b32 v4, 2, v2
  v_cmp_eq_u32 s[80:81], v3, v4
  v_lshrrev_b32 v4, 1, v2
  v_xor_b32 v5, v3, v4
  v_and_b32 v6, 7, v2
  v_lshlrev_b32 v6, 7, v6
  v_lshl_add_u32 v5, v5, 4, v6
  v_lshrrev_b32 v7, 3, v2
  s_lshl_b32 s63, s58, 12
  s_add_u32 s63, s63, 98304
  v_lshl_add_u32 v21, v7, 11, v5
  v_add_u32 v21, s63, v21
  v_xor_b32 v22, 64, v21
  v_lshl_add_u32 v23, v7, 10, v5
  v_add_u32 v23, 147456, v23
  v_xor_b32 v24, 64, v23
  v_lshrrev_b32 v5, 1, v3
  v_xor_b32 v5, v5, v4
  v_lshl_add_u32 v5, v5, 4, v6
  v_lshl_add_u32 v5, v7, 11, v5
  v_and_b32 v4, 1, v3
  v_lshl_add_u32 v5, v4, 3, v5
  s_mul_i32 s63, s60, 11
  s_lshr_b32 s63, s63, 5
  s_mul_i32 s63, s63, 3
  s_sub_u32 s63, s60, s63
  s_lshl_b32 s63, s63, 14
  s_and_b32 s64, s58, 1
  s_lshl_b32 s64, s64, 10
  s_add_u32 s63, s63, s64
  s_lshr_b32 s64, s58, 1
  s_lshl_b32 s64, s64, 12
  s_add_u32 s63, s63, s64
  s_lshl_b32 s64, s61, 13
  s_add_u32 s63, s63, s64
  s_add_u32 s63, s63, 98304
  v_xor_b32 v25, 0, v5
  v_add_u32 v25, s63, v25
  v_xor_b32 v26, 32, v5
  v_add_u32 v26, s63, v26
  v_xor_b32 v27, 64, v5
  v_add_u32 v27, s63, v27
  v_xor_b32 v28, 96, v5
  v_add_u32 v28, s63, v28
  v_lshrrev_b32 v7, 2, v2
  v_lshl_add_u32 v6, v3, 2, v7
  v_mul_u32_u24 v6, 224, v6
  v_and_b32 v7, 3, v2
  v_lshl_add_u32 v5, v7, 3, v6
  s_lshl_b32 s63, s58, 5
  s_add_u32 s63, s63, 0
  v_add_u32 v46, s63, v5
  s_cmp_eq_u32 s58, 3
  s_cselect_b32 s90, 0, 128
  v_add_u32 v47, s90, v46
  s_lshl_b32 s63, s100, 4
  s_add_u32 s63, s63, s101
  s_mul_i32 s63, s63, 896
  s_lshl_b32 s64, s58, 6
  s_add_u32 s63, s63, s64
  s_add_u32 s63, s63, 8192
  v_and_b32 v4, 1, v3
  v_mul_u32_u24 v4, 448, v4
  v_lshl_add_u32 v4, v2, 2, v4
  v_and_b32 v5, 2, v3
  v_mul_u32_u24 v5, s90, v5
  v_add3_u32 v29, v4, v5, s63
  s_waitcnt lgkmcnt(0)
  s_mov_b32 s48, s22
  s_and_b32 s49, s23, 0xffff
  s_mov_b32 s50, 16777216
  s_mov_b32 s51, 0x20000
  s_mov_b32 s44, s18
  s_and_b32 s45, s19, 0xffff
  s_mov_b32 s46, 2097152
  s_mov_b32 s47, 0x20000
  s_mov_b32 s52, s20
  s_and_b32 s53, s21, 0xffff
  s_mov_b32 s54, 256
  s_mov_b32 s55, 0x20000
  buffer_load_dword v191, v30, s[24:27], 0 offen
  s_barrier
  ds_read_b128 a[0:3], v21 offset:0
  ds_read_b128 a[4:7], v21 offset:1024
  ds_read_b128 a[8:11], v22 offset:0
  ds_read_b128 a[12:15], v22 offset:1024
  s_mov_b64 exec, s[84:85]
  ds_read_b128 a[16:19], v23 offset:0
  ds_read_b128 a[20:23], v24 offset:0
  s_mov_b64 exec, -1
  s_cmp_eq_u32 s60, 0
  s_cbranch_scc0 L_res0
  ds_read_b64 v[32:33], v25
  ds_read_b64 v[34:35], v26
  ds_read_b64 v[36:37], v27
  ds_read_b64 v[38:39], v28
L_res0:
  ds_read_b64_tr_b16 v[48:49], v10 offset:0
  ds_read_b64_tr_b16 v[50:51], v10 offset:256
  ds_read_b64_tr_b16 v[52:53], v11 offset:0
  ds_read_b64_tr_b16 v[54:55], v11 offset:256
  ds_read_b64_tr_b16 v[56:57], v10 offset:1024
  ds_read_b64_tr_b16 v[58:59], v10 offset:1280
  ds_read_b64_tr_b16 v[60:61], v11 offset:1024
  ds_read_b64_tr_b16 v[62:63], v11 offset:1280
  ds_read_b64_tr_b16 v[64:65], v10 offset:2048
  ds_read_b64_tr_b16 v[66:67], v10 offset:2304
  ds_read_b64_tr_b16 v[68:69], v11 offset:2048
  ds_read_b64_tr_b16 v[70:71], v11 offset:2304
  ds_read_b64_tr_b16 v[72:73], v14 offset:0
  ds_read_b64_tr_b16 v[74:75], v14 offset:256
  s_waitcnt lgkmcnt(15)
  v_mfma_f32_16x16x32_bf16 v[164:167], a[0:3], a[0:3], 0
  ds_read_b64_tr_b16 v[76:77], v10 offset:6144
  s_waitcnt lgkmcnt(15)
  v_mfma_f32_16x16x32_bf16 v[168:171], a[4:7], a[4:7], 0
  ds_read_b64_tr_b16 v[78:79], v10 offset:6400
  s_waitcnt lgkmcnt(15)
  v_mfma_f32_16x16x32_bf16 v[172:175], a[16:19], a[16:19], 0
  ds_read_b64_tr_b16 v[80:81], v11 offset:6144
  v_mfma_f32_16x16x32_bf16 v[176:179], v[40:43], a[0:3], 0
  buffer_load_dword v188, v30, s[24:27], s72 offen
  v_mfma_f32_16x16x32_bf16 v[180:183], v[40:43], a[4:7], 0
  ds_read_b64_tr_b16 v[82:83], v11 offset:6400
  s_waitcnt lgkmcnt(15)
  v_mfma_f32_16x16x32_bf16 v[108:111], v[48:51], a[0:3], 0
  ds_read_b64_tr_b16 v[84:85], v10 offset:7168
  v_mfma_f32_16x16x32_bf16 v[132:135], v[48:51], a[4:7], 0
  ds_read_b64_tr_b16 v[86:87], v10 offset:7424
  s_waitcnt lgkmcnt(15)
  v_mfma_f32_16x16x32_bf16 v[112:115], v[52:55], a[0:3], 0
  ds_read_b64_tr_b16 v[88:89], v11 offset:7168
  v_mfma_f32_16x16x32_bf16 v[136:139], v[52:55], a[4:7], 0
  ds_read_b64_tr_b16 v[90:91], v11 offset:7424
  s_waitcnt lgkmcnt(15)
  v_mfma_f32_16x16x32_bf16 v[116:119], v[56:59], a[0:3], 0
  ds_read_b64_tr_b16 v[92:93], v10 offset:8192
  v_mfma_f32_16x16x32_bf16 v[140:143], v[56:59], a[4:7], 0
  ds_read_b64_tr_b16 v[94:95], v10 offset:8448
  s_waitcnt lgkmcnt(15)
  v_mfma_f32_16x16x32_bf16 v[120:123], v[60:63], a[0:3], 0
  ds_read_b64_tr_b16 v[96:97], v11 offset:8192
  v_mfma_f32_16x16x32_bf16 v[144:147], v[60:63], a[4:7], 0
  ds_read_b64_tr_b16 v[98:99], v11 offset:8448
  s_waitcnt lgkmcnt(15)
  v_mfma_f32_16x16x32_bf16 v[124:127], v[64:67], a[0:3], 0
  ds_read_b64_tr_b16 v[100:101], v14 offset:6144
  v_mfma_f32_16x16x32_bf16 v[148:151], v[64:67], a[4:7], 0
  ds_read_b64_tr_b16 v[102:103], v14 offset:6400
  s_waitcnt lgkmcnt(15)
  v_mfma_f32_16x16x32_bf16 v[128:131], v[68:71], a[0:3], 0
  ds_read_b64_tr_b16 v[104:105], v16 offset:0
  v_mfma_f32_16x16x32_bf16 v[152:155], v[68:71], a[4:7], 0
  ds_read_b64_tr_b16 v[106:107], v16 offset:256
  s_waitcnt lgkmcnt(15)
  v_mfma_f32_16x16x32_bf16 v[156:159], v[72:75], a[16:19], 0
  v_mfma_f32_16x16x32_bf16 v[164:167], a[8:11], a[8:11], v[164:167]
  s_barrier
  v_mfma_f32_16x16x32_bf16 v[168:171], a[12:15], a[12:15], v[168:171]
  ds_read_b128 a[24:27], v21 offset:16384
  v_mfma_f32_16x16x32_bf16 v[172:175], a[20:23], a[20:23], v[172:175]
  ds_read_b128 a[28:31], v21 offset:17408
  v_mfma_f32_16x16x32_bf16 v[176:179], v[40:43], a[8:11], v[176:179]
  ds_read_b128 a[32:35], v22 offset:16384
  v_mfma_f32_16x16x32_bf16 v[180:183], v[40:43], a[12:15], v[180:183]
  ds_read_b128 a[36:39], v22 offset:17408
  s_waitcnt lgkmcnt(4)
  v_mfma_f32_16x16x32_bf16 v[108:111], v[76:79], a[8:11], v[108:111]
  s_mov_b64 exec, s[84:85]
  ds_read_b128 a[40:43], v23 offset:2048
  ds_read_b128 a[44:47], v24 offset:2048
  s_mov_b64 exec, -1
  v_mfma_f32_16x16x32_bf16 v[132:135], v[76:79], a[12:15], v[132:135]
  s_cmp_eq_u32 s60, 1
  s_cbranch_scc0 L_res1
  ds_read_b64 v[32:33], v25
  ds_read_b64 v[34:35], v26
  ds_read_b64 v[36:37], v27
  ds_read_b64 v[38:39], v28
L_res1:
  v_mfma_f32_16x16x32_bf16 v[112:115], v[80:83], a[8:11], v[112:115]
  ds_read_b64_tr_b16 v[48:49], v10 offset:12288
  v_mfma_f32_16x16x32_bf16 v[136:139], v[80:83], a[12:15], v[136:139]
  ds_read_b64_tr_b16 v[50:51], v10 offset:12544
  v_mfma_f32_16x16x32_bf16 v[116:119], v[84:87], a[8:11], v[116:119]
  ds_read_b64_tr_b16 v[52:53], v11 offset:12288
  v_mfma_f32_16x16x32_bf16 v[140:143], v[84:87], a[12:15], v[140:143]
  ds_read_b64_tr_b16 v[54:55], v11 offset:12544
  v_mfma_f32_16x16x32_bf16 v[120:123], v[88:91], a[8:11], v[120:123]
  ds_read_b64_tr_b16 v[56:57], v10 offset:13312
  v_mfma_f32_16x16x32_bf16 v[144:147], v[88:91], a[12:15], v[144:147]
  ds_read_b64_tr_b16 v[58:59], v10 offset:13568
  v_mfma_f32_16x16x32_bf16 v[124:127], v[92:95], a[8:11], v[124:127]
  ds_read_b64_tr_b16 v[60:61], v11 offset:13312
  v_mfma_f32_16x16x32_bf16 v[148:151], v[92:95], a[12:15], v[148:151]
  ds_read_b64_tr_b16 v[62:63], v11 offset:13568
  v_mfma_f32_16x16x32_bf16 v[128:131], v[96:99], a[8:11], v[128:131]
  ds_read_b64_tr_b16 v[64:65], v10 offset:14336
  v_mfma_f32_16x16x32_bf16 v[152:155], v[96:99], a[12:15], v[152:155]
  ds_read_b64_tr_b16 v[66:67], v10 offset:14592
  v_mfma_f32_16x16x32_bf16 v[156:159], v[100:103], a[20:23], v[156:159]
  ds_read_b64_tr_b16 v[68:69], v11 offset:14336
  v_mfma_f32_16x16x32_bf16 v[160:163], v[104:107], v[40:43], 0
  ds_read_b64_tr_b16 v[70:71], v11 offset:14592
  ds_read_b64_tr_b16 v[72:73], v14 offset:12288
  ds_read_b64_tr_b16 v[74:75], v14 offset:12544
  s_waitcnt lgkmcnt(15)
  v_mfma_f32_16x16x32_bf16 v[164:167], a[24:27], a[24:27], v[164:167]
  ds_read_b64_tr_b16 v[76:77], v10 offset:18432
  v_mfma_f32_16x16x32_bf16 v[168:171], a[28:31], a[28:31], v[168:171]
  ds_read_b64_tr_b16 v[78:79], v10 offset:18688
  v_mfma_f32_16x16x32_bf16 v[172:175], a[40:43], a[40:43], v[172:175]
  ds_read_b64_tr_b16 v[80:81], v11 offset:18432
  v_mfma_f32_16x16x32_bf16 v[176:179], v[40:43], a[24:27], v[176:179]
  ds_read_b64_tr_b16 v[82:83], v11 offset:18688
  v_mfma_f32_16x16x32_bf16 v[180:183], v[40:43], a[28:31], v[180:183]
  ds_read_b64_tr_b16 v[84:85], v10 offset:19456
  s_waitcnt lgkmcnt(5)
  v_mfma_f32_16x16x32_bf16 v[108:111], v[48:51], a[24:27], v[108:111]
  ds_read_b64_tr_b16 v[86:87], v10 offset:19712
  v_mfma_f32_16x16x32_bf16 v[132:135], v[48:51], a[28:31], v[132:135]
  ds_read_b64_tr_b16 v[88:89], v11 offset:19456
  v_mfma_f32_16x16x32_bf16 v[112:115], v[52:55], a[24:27], v[112:115]
  ds_read_b64_tr_b16 v[90:91], v11 offset:19712
  v_mfma_f32_16x16x32_bf16 v[136:139], v[52:55], a[28:31], v[136:139]
  ds_read_b64_tr_b16 v[92:93], v10 offset:20480
  v_mfma_f32_16x16x32_bf16 v[116:119], v[56:59], a[24:27], v[116:119]
  ds_read_b64_tr_b16 v[94:95], v10 offset:20736
  v_mfma_f32_16x16x32_bf16 v[140:143], v[56:59], a[28:31], v[140:143]
  ds_read_b64_tr_b16 v[96:97], v11 offset:20480
  v_mfma_f32_16x16x32_bf16 v[120:123], v[60:63], a[24:27], v[120:123]
  ds_read_b64_tr_b16 v[98:99], v11 offset:20736
  v_mfma_f32_16x16x32_bf16 v[144:147], v[60:63], a[28:31], v[144:147]
  ds_read_b64_tr_b16 v[100:101], v14 offset:18432
  v_mfma_f32_16x16x32_bf16 v[124:127], v[64:67], a[24:27], v[124:127]
  ds_read_b64_tr_b16 v[102:103], v14 offset:18688
  v_mfma_f32_16x16x32_bf16 v[148:151], v[64:67], a[28:31], v[148:151]
  ds_read_b64_tr_b16 v[104:105], v16 offset:12288
  v_mfma_f32_16x16x32_bf16 v[128:131], v[68:71], a[24:27], v[128:131]
  ds_read_b64_tr_b16 v[106:107], v16 offset:12544
  v_mfma_f32_16x16x32_bf16 v[152:155], v[68:71], a[28:31], v[152:155]
  v_mfma_f32_16x16x32_bf16 v[156:159], v[72:75], a[40:43], v[156:159]
  v_mfma_f32_16x16x32_bf16 v[164:167], a[32:35], a[32:35], v[164:167]
  s_barrier
  v_mfma_f32_16x16x32_bf16 v[168:171], a[36:39], a[36:39], v[168:171]
  ds_read_b128 a[0:3], v21 offset:32768
  v_mfma_f32_16x16x32_bf16 v[172:175], a[44:47], a[44:47], v[172:175]
  ds_read_b128 a[4:7], v21 offset:33792
  v_mfma_f32_16x16x32_bf16 v[176:179], v[40:43], a[32:35], v[176:179]
  ds_read_b128 a[8:11], v22 offset:32768
  v_mfma_f32_16x16x32_bf16 v[180:183], v[40:43], a[36:39], v[180:183]
  ds_read_b128 a[12:15], v22 offset:33792
  s_waitcnt lgkmcnt(4)
  v_mfma_f32_16x16x32_bf16 v[108:111], v[76:79], a[32:35], v[108:111]
  s_mov_b64 exec, s[84:85]
  ds_read_b128 a[16:19], v23 offset:4096
  ds_read_b128 a[20:23], v24 offset:4096
  s_mov_b64 exec, -1
  v_mfma_f32_16x16x32_bf16 v[132:135], v[76:79], a[36:39], v[132:135]
  s_cmp_eq_u32 s60, 2
  s_cbranch_scc0 L_res2
  ds_read_b64 v[32:33], v25
  ds_read_b64 v[34:35], v26
  ds_read_b64 v[36:37], v27
  ds_read_b64 v[38:39], v28
L_res2:
  v_mfma_f32_16x16x32_bf16 v[112:115], v[80:83], a[32:35], v[112:115]
  ds_read_b64_tr_b16 v[48:49], v10 offset:24576
  v_mfma_f32_16x16x32_bf16 v[136:139], v[80:83], a[36:39], v[136:139]
  ds_read_b64_tr_b16 v[50:51], v10 offset:24832
  v_mfma_f32_16x16x32_bf16 v[116:119], v[84:87], a[32:35], v[116:119]
  ds_read_b64_tr_b16 v[52:53], v11 offset:24576
  v_mfma_f32_16x16x32_bf16 v[140:143], v[84:87], a[36:39], v[140:143]
  ds_read_b64_tr_b16 v[54:55], v11 offset:24832
  v_mfma_f32_16x16x32_bf16 v[120:123], v[88:91], a[32:35], v[120:123]
  ds_read_b64_tr_b16 v[56:57], v10 offset:25600
  v_mfma_f32_16x16x32_bf16 v[144:147], v[88:91], a[36:39], v[144:147]
  ds_read_b64_tr_b16 v[58:59], v10 offset:25856
  v_mfma_f32_16x16x32_bf16 v[124:127], v[92:95], a[32:35], v[124:127]
  ds_read_b64_tr_b16 v[60:61], v11 offset:25600
  v_mfma_f32_16x16x32_bf16 v[148:151], v[92:95], a[36:39], v[148:151]
  ds_read_b64_tr_b16 v[62:63], v11 offset:25856
  v_mfma_f32_16x16x32_bf16 v[128:131], v[96:99], a[32:35], v[128:131]
  ds_read_b64_tr_b16 v[64:65], v10 offset:26624
  v_mfma_f32_16x16x32_bf16 v[152:155], v[96:99], a[36:39], v[152:155]
  ds_read_b64_tr_b16 v[66:67], v10 offset:26880
  v_mfma_f32_16x16x32_bf16 v[156:159], v[100:103], a[44:47], v[156:159]
  ds_read_b64_tr_b16 v[68:69], v11 offset:26624
  v_mfma_f32_16x16x32_bf16 v[160:163], v[104:107], v[40:43], v[160:163]
  ds_read_b64_tr_b16 v[70:71], v11 offset:26880
  ds_read_b64_tr_b16 v[72:73], v14 offset:24576
  ds_read_b64_tr_b16 v[74:75], v14 offset:24832
  s_waitcnt lgkmcnt(15)
  v_mfma_f32_16x16x32_bf16 v[164:167], a[0:3], a[0:3], v[164:167]
  ds_read_b64_tr_b16 v[76:77], v10 offset:30720
  v_mfma_f32_16x16x32_bf16 v[168:171], a[4:7], a[4:7], v[168:171]
  ds_read_b64_tr_b16 v[78:79], v10 offset:30976
  v_mfma_f32_16x16x32_bf16 v[172:175], a[16:19], a[16:19], v[172:175]
  ds_read_b64_tr_b16 v[80:81], v11 offset:30720
  v_mfma_f32_16x16x32_bf16 v[176:179], v[40:43], a[0:3], v[176:179]
  ds_read_b64_tr_b16 v[82:83], v11 offset:30976
  v_mfma_f32_16x16x32_bf16 v[180:183], v[40:43], a[4:7], v[180:183]
  ds_read_b64_tr_b16 v[84:85], v10 offset:31744
  s_waitcnt lgkmcnt(5)
  v_mfma_f32_16x16x32_bf16 v[108:111], v[48:51], a[0:3], v[108:111]
  ds_read_b64_tr_b16 v[86:87], v10 offset:32000
  v_mfma_f32_16x16x32_bf16 v[132:135], v[48:51], a[4:7], v[132:135]
  ds_read_b64_tr_b16 v[88:89], v11 offset:31744
  v_mfma_f32_16x16x32_bf16 v[112:115], v[52:55], a[0:3], v[112:115]
  ds_read_b64_tr_b16 v[90:91], v11 offset:32000
  v_mfma_f32_16x16x32_bf16 v[136:139], v[52:55], a[4:7], v[136:139]
  ds_read_b64_tr_b16 v[92:93], v10 offset:32768
  v_mfma_f32_16x16x32_bf16 v[116:119], v[56:59], a[0:3], v[116:119]
  ds_read_b64_tr_b16 v[94:95], v10 offset:33024
  v_mfma_f32_16x16x32_bf16 v[140:143], v[56:59], a[4:7], v[140:143]
  ds_read_b64_tr_b16 v[96:97], v11 offset:32768
  v_mfma_f32_16x16x32_bf16 v[120:123], v[60:63], a[0:3], v[120:123]
  ds_read_b64_tr_b16 v[98:99], v11 offset:33024
  v_mfma_f32_16x16x32_bf16 v[144:147], v[60:63], a[4:7], v[144:147]
  ds_read_b64_tr_b16 v[100:101], v14 offset:30720
  v_mfma_f32_16x16x32_bf16 v[124:127], v[64:67], a[0:3], v[124:127]
  ds_read_b64_tr_b16 v[102:103], v14 offset:30976
  v_mfma_f32_16x16x32_bf16 v[148:151], v[64:67], a[4:7], v[148:151]
  ds_read_b64_tr_b16 v[104:105], v16 offset:24576
  v_mfma_f32_16x16x32_bf16 v[128:131], v[68:71], a[0:3], v[128:131]
  ds_read_b64_tr_b16 v[106:107], v16 offset:24832
  v_mfma_f32_16x16x32_bf16 v[152:155], v[68:71], a[4:7], v[152:155]
  v_mfma_f32_16x16x32_bf16 v[156:159], v[72:75], a[16:19], v[156:159]
  v_mfma_f32_16x16x32_bf16 v[164:167], a[8:11], a[8:11], v[164:167]
  s_barrier
  v_mfma_f32_16x16x32_bf16 v[168:171], a[12:15], a[12:15], v[168:171]
  ds_read_b128 a[24:27], v21 offset:0
  v_mfma_f32_16x16x32_bf16 v[172:175], a[20:23], a[20:23], v[172:175]
  ds_read_b128 a[28:31], v21 offset:1024
  v_mfma_f32_16x16x32_bf16 v[176:179], v[40:43], a[8:11], v[176:179]
  ds_read_b128 a[32:35], v22 offset:0
  v_mfma_f32_16x16x32_bf16 v[180:183], v[40:43], a[12:15], v[180:183]
  ds_read_b128 a[36:39], v22 offset:1024
  s_waitcnt lgkmcnt(4)
  v_mfma_f32_16x16x32_bf16 v[108:111], v[76:79], a[8:11], v[108:111]
  s_mov_b64 exec, s[84:85]
  ds_read_b128 a[40:43], v23 offset:6144
  ds_read_b128 a[44:47], v24 offset:6144
  s_mov_b64 exec, -1
  v_mfma_f32_16x16x32_bf16 v[132:135], v[76:79], a[12:15], v[132:135]
  s_cmp_eq_u32 s60, 3
  s_cbranch_scc0 L_res3
  ds_read_b64 v[32:33], v25
  ds_read_b64 v[34:35], v26
  ds_read_b64 v[36:37], v27
  ds_read_b64 v[38:39], v28
L_res3:
  v_mfma_f32_16x16x32_bf16 v[112:115], v[80:83], a[8:11], v[112:115]
  ds_read_b64_tr_b16 v[48:49], v10 offset:36864
  v_mfma_f32_16x16x32_bf16 v[136:139], v[80:83], a[12:15], v[136:139]
  ds_read_b64_tr_b16 v[50:51], v10 offset:37120
  v_mfma_f32_16x16x32_bf16 v[116:119], v[84:87], a[8:11], v[116:119]
  ds_read_b64_tr_b16 v[52:53], v11 offset:36864
  v_mfma_f32_16x16x32_bf16 v[140:143], v[84:87], a[12:15], v[140:143]
  ds_read_b64_tr_b16 v[54:55], v11 offset:37120
  v_mfma_f32_16x16x32_bf16 v[120:123], v[88:91], a[8:11], v[120:123]
  ds_read_b64_tr_b16 v[56:57], v10 offset:37888
  v_mfma_f32_16x16x32_bf16 v[144:147], v[88:91], a[12:15], v[144:147]
  ds_read_b64_tr_b16 v[58:59], v10 offset:38144
  v_mfma_f32_16x16x32_bf16 v[124:127], v[92:95], a[8:11], v[124:127]
  ds_read_b64_tr_b16 v[60:61], v11 offset:37888
  v_mfma_f32_16x16x32_bf16 v[148:151], v[92:95], a[12:15], v[148:151]
  ds_read_b64_tr_b16 v[62:63], v11 offset:38144
  v_mfma_f32_16x16x32_bf16 v[128:131], v[96:99], a[8:11], v[128:131]
  ds_read_b64_tr_b16 v[64:65], v10 offset:38912
  v_mfma_f32_16x16x32_bf16 v[152:155], v[96:99], a[12:15], v[152:155]
  ds_read_b64_tr_b16 v[66:67], v10 offset:39168
  v_mfma_f32_16x16x32_bf16 v[156:159], v[100:103], a[20:23], v[156:159]
  ds_read_b64_tr_b16 v[68:69], v11 offset:38912
  v_mfma_f32_16x16x32_bf16 v[160:163], v[104:107], v[40:43], v[160:163]
  ds_read_b64_tr_b16 v[70:71], v11 offset:39168
  ds_read_b64_tr_b16 v[72:73], v14 offset:36864
  ds_read_b64_tr_b16 v[74:75], v14 offset:37120
  s_waitcnt lgkmcnt(15)
  v_mfma_f32_16x16x32_bf16 v[164:167], a[24:27], a[24:27], v[164:167]
  ds_read_b64_tr_b16 v[76:77], v10 offset:43008
  v_mfma_f32_16x16x32_bf16 v[168:171], a[28:31], a[28:31], v[168:171]
  ds_read_b64_tr_b16 v[78:79], v10 offset:43264
  v_mfma_f32_16x16x32_bf16 v[172:175], a[40:43], a[40:43], v[172:175]
  ds_read_b64_tr_b16 v[80:81], v11 offset:43008
  v_mfma_f32_16x16x32_bf16 v[176:179], v[40:43], a[24:27], v[176:179]
  ds_read_b64_tr_b16 v[82:83], v11 offset:43264
  v_mfma_f32_16x16x32_bf16 v[180:183], v[40:43], a[28:31], v[180:183]
  ds_read_b64_tr_b16 v[84:85], v10 offset:44032
  s_waitcnt lgkmcnt(5)
  v_mfma_f32_16x16x32_bf16 v[108:111], v[48:51], a[24:27], v[108:111]
  ds_read_b64_tr_b16 v[86:87], v10 offset:44288
  v_mfma_f32_16x16x32_bf16 v[132:135], v[48:51], a[28:31], v[132:135]
  ds_read_b64_tr_b16 v[88:89], v11 offset:44032
  v_mfma_f32_16x16x32_bf16 v[112:115], v[52:55], a[24:27], v[112:115]
  ds_read_b64_tr_b16 v[90:91], v11 offset:44288
  v_mfma_f32_16x16x32_bf16 v[136:139], v[52:55], a[28:31], v[136:139]
  ds_read_b64_tr_b16 v[92:93], v10 offset:45056
  v_mfma_f32_16x16x32_bf16 v[116:119], v[56:59], a[24:27], v[116:119]
  ds_read_b64_tr_b16 v[94:95], v10 offset:45312
  v_mfma_f32_16x16x32_bf16 v[140:143], v[56:59], a[28:31], v[140:143]
  ds_read_b64_tr_b16 v[96:97], v11 offset:45056
  v_mfma_f32_16x16x32_bf16 v[120:123], v[60:63], a[24:27], v[120:123]
  ds_read_b64_tr_b16 v[98:99], v11 offset:45312
  v_mfma_f32_16x16x32_bf16 v[144:147], v[60:63], a[28:31], v[144:147]
  ds_read_b64_tr_b16 v[100:101], v14 offset:43008
  v_mfma_f32_16x16x32_bf16 v[124:127], v[64:67], a[24:27], v[124:127]
  ds_read_b64_tr_b16 v[102:103], v14 offset:43264
  v_mfma_f32_16x16x32_bf16 v[148:151], v[64:67], a[28:31], v[148:151]
  ds_read_b64_tr_b16 v[104:105], v16 offset:36864
  v_mfma_f32_16x16x32_bf16 v[128:131], v[68:71], a[24:27], v[128:131]
  ds_read_b64_tr_b16 v[106:107], v16 offset:37120
  v_mfma_f32_16x16x32_bf16 v[152:155], v[68:71], a[28:31], v[152:155]
  v_mfma_f32_16x16x32_bf16 v[156:159], v[72:75], a[40:43], v[156:159]
  v_mfma_f32_16x16x32_bf16 v[164:167], a[32:35], a[32:35], v[164:167]
  s_barrier
  v_mfma_f32_16x16x32_bf16 v[168:171], a[36:39], a[36:39], v[168:171]
  ds_read_b128 a[0:3], v21 offset:16384
  v_mfma_f32_16x16x32_bf16 v[172:175], a[44:47], a[44:47], v[172:175]
  ds_read_b128 a[4:7], v21 offset:17408
  v_mfma_f32_16x16x32_bf16 v[176:179], v[40:43], a[32:35], v[176:179]
  ds_read_b128 a[8:11], v22 offset:16384
  v_mfma_f32_16x16x32_bf16 v[180:183], v[40:43], a[36:39], v[180:183]
  ds_read_b128 a[12:15], v22 offset:17408
  s_waitcnt lgkmcnt(4)
  v_mfma_f32_16x16x32_bf16 v[108:111], v[76:79], a[32:35], v[108:111]
  s_mov_b64 exec, s[84:85]
  ds_read_b128 a[16:19], v23 offset:8192
  ds_read_b128 a[20:23], v24 offset:8192
  s_mov_b64 exec, -1
  v_mfma_f32_16x16x32_bf16 v[132:135], v[76:79], a[36:39], v[132:135]
  s_cmp_eq_u32 s60, 4
  s_cbranch_scc0 L_res4
  ds_read_b64 v[32:33], v25
  ds_read_b64 v[34:35], v26
  ds_read_b64 v[36:37], v27
  ds_read_b64 v[38:39], v28
L_res4:
  v_mfma_f32_16x16x32_bf16 v[112:115], v[80:83], a[32:35], v[112:115]
  ds_read_b64_tr_b16 v[48:49], v10 offset:49152
  v_mfma_f32_16x16x32_bf16 v[136:139], v[80:83], a[36:39], v[136:139]
  ds_read_b64_tr_b16 v[50:51], v10 offset:49408
  v_mfma_f32_16x16x32_bf16 v[116:119], v[84:87], a[32:35], v[116:119]
  ds_read_b64_tr_b16 v[52:53], v11 offset:49152
  v_mfma_f32_16x16x32_bf16 v[140:143], v[84:87], a[36:39], v[140:143]
  ds_read_b64_tr_b16 v[54:55], v11 offset:49408
  v_mfma_f32_16x16x32_bf16 v[120:123], v[88:91], a[32:35], v[120:123]
  ds_read_b64_tr_b16 v[56:57], v10 offset:50176
  v_mfma_f32_16x16x32_bf16 v[144:147], v[88:91], a[36:39], v[144:147]
  ds_read_b64_tr_b16 v[58:59], v10 offset:50432
  v_mfma_f32_16x16x32_bf16 v[124:127], v[92:95], a[32:35], v[124:127]
  ds_read_b64_tr_b16 v[60:61], v11 offset:50176
  v_mfma_f32_16x16x32_bf16 v[148:151], v[92:95], a[36:39], v[148:151]
  ds_read_b64_tr_b16 v[62:63], v11 offset:50432
  v_mfma_f32_16x16x32_bf16 v[128:131], v[96:99], a[32:35], v[128:131]
  ds_read_b64_tr_b16 v[64:65], v10 offset:51200
  v_mfma_f32_16x16x32_bf16 v[152:155], v[96:99], a[36:39], v[152:155]
  ds_read_b64_tr_b16 v[66:67], v10 offset:51456
  v_mfma_f32_16x16x32_bf16 v[156:159], v[100:103], a[44:47], v[156:159]
  ds_read_b64_tr_b16 v[68:69], v11 offset:51200
  v_mfma_f32_16x16x32_bf16 v[160:163], v[104:107], v[40:43], v[160:163]
  ds_read_b64_tr_b16 v[70:71], v11 offset:51456
  ds_read_b64_tr_b16 v[72:73], v14 offset:49152
  ds_read_b64_tr_b16 v[74:75], v14 offset:49408
  s_waitcnt lgkmcnt(15)
  v_mfma_f32_16x16x32_bf16 v[164:167], a[0:3], a[0:3], v[164:167]
  ds_read_b64_tr_b16 v[76:77], v10 offset:55296
  v_mfma_f32_16x16x32_bf16 v[168:171], a[4:7], a[4:7], v[168:171]
  ds_read_b64_tr_b16 v[78:79], v10 offset:55552
  v_mfma_f32_16x16x32_bf16 v[172:175], a[16:19], a[16:19], v[172:175]
  ds_read_b64_tr_b16 v[80:81], v11 offset:55296
  v_mfma_f32_16x16x32_bf16 v[176:179], v[40:43], a[0:3], v[176:179]
  ds_read_b64_tr_b16 v[82:83], v11 offset:55552
  v_mfma_f32_16x16x32_bf16 v[180:183], v[40:43], a[4:7], v[180:183]
  ds_read_b64_tr_b16 v[84:85], v10 offset:56320
  s_waitcnt lgkmcnt(5)
  v_mfma_f32_16x16x32_bf16 v[108:111], v[48:51], a[0:3], v[108:111]
  ds_read_b64_tr_b16 v[86:87], v10 offset:56576
  v_mfma_f32_16x16x32_bf16 v[132:135], v[48:51], a[4:7], v[132:135]
  ds_read_b64_tr_b16 v[88:89], v11 offset:56320
  v_mfma_f32_16x16x32_bf16 v[112:115], v[52:55], a[0:3], v[112:115]
  ds_read_b64_tr_b16 v[90:91], v11 offset:56576
  v_mfma_f32_16x16x32_bf16 v[136:139], v[52:55], a[4:7], v[136:139]
  ds_read_b64_tr_b16 v[92:93], v10 offset:57344
  v_mfma_f32_16x16x32_bf16 v[116:119], v[56:59], a[0:3], v[116:119]
  ds_read_b64_tr_b16 v[94:95], v10 offset:57600
  v_mfma_f32_16x16x32_bf16 v[140:143], v[56:59], a[4:7], v[140:143]
  ds_read_b64_tr_b16 v[96:97], v11 offset:57344
  v_mfma_f32_16x16x32_bf16 v[120:123], v[60:63], a[0:3], v[120:123]
  ds_read_b64_tr_b16 v[98:99], v11 offset:57600
  v_mfma_f32_16x16x32_bf16 v[144:147], v[60:63], a[4:7], v[144:147]
  ds_read_b64_tr_b16 v[100:101], v14 offset:55296
  v_mfma_f32_16x16x32_bf16 v[124:127], v[64:67], a[0:3], v[124:127]
  ds_read_b64_tr_b16 v[102:103], v14 offset:55552
  v_mfma_f32_16x16x32_bf16 v[148:151], v[64:67], a[4:7], v[148:151]
  ds_read_b64_tr_b16 v[104:105], v16 offset:49152
  v_mfma_f32_16x16x32_bf16 v[128:131], v[68:71], a[0:3], v[128:131]
  ds_read_b64_tr_b16 v[106:107], v16 offset:49408
  v_mfma_f32_16x16x32_bf16 v[152:155], v[68:71], a[4:7], v[152:155]
  v_mfma_f32_16x16x32_bf16 v[156:159], v[72:75], a[16:19], v[156:159]
  v_mfma_f32_16x16x32_bf16 v[164:167], a[8:11], a[8:11], v[164:167]
  s_barrier
  v_mfma_f32_16x16x32_bf16 v[168:171], a[12:15], a[12:15], v[168:171]
  ds_read_b128 a[24:27], v21 offset:32768
  v_mfma_f32_16x16x32_bf16 v[172:175], a[20:23], a[20:23], v[172:175]
  ds_read_b128 a[28:31], v21 offset:33792
  v_mfma_f32_16x16x32_bf16 v[176:179], v[40:43], a[8:11], v[176:179]
  ds_read_b128 a[32:35], v22 offset:32768
  v_mfma_f32_16x16x32_bf16 v[180:183], v[40:43], a[12:15], v[180:183]
  ds_read_b128 a[36:39], v22 offset:33792
  s_waitcnt lgkmcnt(4)
  v_mfma_f32_16x16x32_bf16 v[108:111], v[76:79], a[8:11], v[108:111]
  s_mov_b64 exec, s[84:85]
  ds_read_b128 a[40:43], v23 offset:10240
  ds_read_b128 a[44:47], v24 offset:10240
  s_mov_b64 exec, -1
  v_mfma_f32_16x16x32_bf16 v[132:135], v[76:79], a[12:15], v[132:135]
  s_cmp_eq_u32 s60, 5
  s_cbranch_scc0 L_res5
  ds_read_b64 v[32:33], v25
  ds_read_b64 v[34:35], v26
  ds_read_b64 v[36:37], v27
  ds_read_b64 v[38:39], v28
L_res5:
  v_mfma_f32_16x16x32_bf16 v[112:115], v[80:83], a[8:11], v[112:115]
  ds_read_b64_tr_b16 v[48:49], v12 offset:0
  v_mfma_f32_16x16x32_bf16 v[136:139], v[80:83], a[12:15], v[136:139]
  ds_read_b64_tr_b16 v[50:51], v12 offset:256
  v_mfma_f32_16x16x32_bf16 v[116:119], v[84:87], a[8:11], v[116:119]
  ds_read_b64_tr_b16 v[52:53], v13 offset:0
  v_mfma_f32_16x16x32_bf16 v[140:143], v[84:87], a[12:15], v[140:143]
  ds_read_b64_tr_b16 v[54:55], v13 offset:256
  v_mfma_f32_16x16x32_bf16 v[120:123], v[88:91], a[8:11], v[120:123]
  ds_read_b64_tr_b16 v[56:57], v12 offset:1024
  v_mfma_f32_16x16x32_bf16 v[144:147], v[88:91], a[12:15], v[144:147]
  ds_read_b64_tr_b16 v[58:59], v12 offset:1280
  v_mfma_f32_16x16x32_bf16 v[124:127], v[92:95], a[8:11], v[124:127]
  ds_read_b64_tr_b16 v[60:61], v13 offset:1024
  v_mfma_f32_16x16x32_bf16 v[148:151], v[92:95], a[12:15], v[148:151]
  ds_read_b64_tr_b16 v[62:63], v13 offset:1280
  v_mfma_f32_16x16x32_bf16 v[128:131], v[96:99], a[8:11], v[128:131]
  ds_read_b64_tr_b16 v[64:65], v12 offset:2048
  v_mfma_f32_16x16x32_bf16 v[152:155], v[96:99], a[12:15], v[152:155]
  ds_read_b64_tr_b16 v[66:67], v12 offset:2304
  v_mfma_f32_16x16x32_bf16 v[156:159], v[100:103], a[20:23], v[156:159]
  ds_read_b64_tr_b16 v[68:69], v13 offset:2048
  v_mfma_f32_16x16x32_bf16 v[160:163], v[104:107], v[40:43], v[160:163]
  ds_read_b64_tr_b16 v[70:71], v13 offset:2304
  ds_read_b64_tr_b16 v[72:73], v15 offset:0
  ds_read_b64_tr_b16 v[74:75], v15 offset:256
  s_waitcnt lgkmcnt(15)
  v_mfma_f32_16x16x32_bf16 v[164:167], a[24:27], a[24:27], v[164:167]
  ds_read_b64_tr_b16 v[76:77], v12 offset:6144
  v_mfma_f32_16x16x32_bf16 v[168:171], a[28:31], a[28:31], v[168:171]
  ds_read_b64_tr_b16 v[78:79], v12 offset:6400
  v_mfma_f32_16x16x32_bf16 v[172:175], a[40:43], a[40:43], v[172:175]
  ds_read_b64_tr_b16 v[80:81], v13 offset:6144
  v_mfma_f32_16x16x32_bf16 v[176:179], v[40:43], a[24:27], v[176:179]
  ds_read_b64_tr_b16 v[82:83], v13 offset:6400
  v_mfma_f32_16x16x32_bf16 v[180:183], v[40:43], a[28:31], v[180:183]
  ds_read_b64_tr_b16 v[84:85], v12 offset:7168
  s_waitcnt lgkmcnt(5)
  v_mfma_f32_16x16x32_bf16 v[108:111], v[48:51], a[24:27], v[108:111]
  ds_read_b64_tr_b16 v[86:87], v12 offset:7424
  v_mfma_f32_16x16x32_bf16 v[132:135], v[48:51], a[28:31], v[132:135]
  ds_read_b64_tr_b16 v[88:89], v13 offset:7168
  v_mfma_f32_16x16x32_bf16 v[112:115], v[52:55], a[24:27], v[112:115]
  ds_read_b64_tr_b16 v[90:91], v13 offset:7424
  v_mfma_f32_16x16x32_bf16 v[136:139], v[52:55], a[28:31], v[136:139]
  ds_read_b64_tr_b16 v[92:93], v12 offset:8192
  v_mfma_f32_16x16x32_bf16 v[116:119], v[56:59], a[24:27], v[116:119]
  ds_read_b64_tr_b16 v[94:95], v12 offset:8448
  v_mfma_f32_16x16x32_bf16 v[140:143], v[56:59], a[28:31], v[140:143]
  ds_read_b64_tr_b16 v[96:97], v13 offset:8192
  v_mfma_f32_16x16x32_bf16 v[120:123], v[60:63], a[24:27], v[120:123]
  ds_read_b64_tr_b16 v[98:99], v13 offset:8448
  v_mfma_f32_16x16x32_bf16 v[144:147], v[60:63], a[28:31], v[144:147]
  ds_read_b64_tr_b16 v[100:101], v15 offset:6144
  v_mfma_f32_16x16x32_bf16 v[124:127], v[64:67], a[24:27], v[124:127]
  ds_read_b64_tr_b16 v[102:103], v15 offset:6400
  v_mfma_f32_16x16x32_bf16 v[148:151], v[64:67], a[28:31], v[148:151]
  ds_read_b64_tr_b16 v[104:105], v44 offset:0
  v_mfma_f32_16x16x32_bf16 v[128:131], v[68:71], a[24:27], v[128:131]
  ds_read_b64_tr_b16 v[106:107], v44 offset:256
  v_mfma_f32_16x16x32_bf16 v[152:155], v[68:71], a[28:31], v[152:155]
  v_mfma_f32_16x16x32_bf16 v[156:159], v[72:75], a[40:43], v[156:159]
  v_mfma_f32_16x16x32_bf16 v[164:167], a[32:35], a[32:35], v[164:167]
  s_barrier
  v_mfma_f32_16x16x32_bf16 v[168:171], a[36:39], a[36:39], v[168:171]
  ds_read_b128 a[0:3], v21 offset:0
  v_mfma_f32_16x16x32_bf16 v[172:175], a[44:47], a[44:47], v[172:175]
  ds_read_b128 a[4:7], v21 offset:1024
  v_mfma_f32_16x16x32_bf16 v[176:179], v[40:43], a[32:35], v[176:179]
  ds_read_b128 a[8:11], v22 offset:0
  v_mfma_f32_16x16x32_bf16 v[180:183], v[40:43], a[36:39], v[180:183]
  ds_read_b128 a[12:15], v22 offset:1024
  s_waitcnt lgkmcnt(4)
  v_mfma_f32_16x16x32_bf16 v[108:111], v[76:79], a[32:35], v[108:111]
  s_mov_b64 exec, s[84:85]
  ds_read_b128 a[16:19], v23 offset:12288
  ds_read_b128 a[20:23], v24 offset:12288
  s_mov_b64 exec, -1
  v_mfma_f32_16x16x32_bf16 v[132:135], v[76:79], a[36:39], v[132:135]
  s_cmp_eq_u32 s60, 6
  s_cbranch_scc0 L_res6
  ds_read_b64 v[32:33], v25
  ds_read_b64 v[34:35], v26
  ds_read_b64 v[36:37], v27
  ds_read_b64 v[38:39], v28
L_res6:
  v_mfma_f32_16x16x32_bf16 v[112:115], v[80:83], a[32:35], v[112:115]
  ds_read_b64_tr_b16 v[48:49], v12 offset:12288
  v_mfma_f32_16x16x32_bf16 v[136:139], v[80:83], a[36:39], v[136:139]
  ds_read_b64_tr_b16 v[50:51], v12 offset:12544
  v_mfma_f32_16x16x32_bf16 v[116:119], v[84:87], a[32:35], v[116:119]
  ds_read_b64_tr_b16 v[52:53], v13 offset:12288
  v_mfma_f32_16x16x32_bf16 v[140:143], v[84:87], a[36:39], v[140:143]
  ds_read_b64_tr_b16 v[54:55], v13 offset:12544
  v_mfma_f32_16x16x32_bf16 v[120:123], v[88:91], a[32:35], v[120:123]
  ds_read_b64_tr_b16 v[56:57], v12 offset:13312
  v_mfma_f32_16x16x32_bf16 v[144:147], v[88:91], a[36:39], v[144:147]
  ds_read_b64_tr_b16 v[58:59], v12 offset:13568
  v_mfma_f32_16x16x32_bf16 v[124:127], v[92:95], a[32:35], v[124:127]
  ds_read_b64_tr_b16 v[60:61], v13 offset:13312
  v_mfma_f32_16x16x32_bf16 v[148:151], v[92:95], a[36:39], v[148:151]
  ds_read_b64_tr_b16 v[62:63], v13 offset:13568
  v_mfma_f32_16x16x32_bf16 v[128:131], v[96:99], a[32:35], v[128:131]
  ds_read_b64_tr_b16 v[64:65], v12 offset:14336
  v_mfma_f32_16x16x32_bf16 v[152:155], v[96:99], a[36:39], v[152:155]
  ds_read_b64_tr_b16 v[66:67], v12 offset:14592
  v_mfma_f32_16x16x32_bf16 v[156:159], v[100:103], a[44:47], v[156:159]
  ds_read_b64_tr_b16 v[68:69], v13 offset:14336
  v_mfma_f32_16x16x32_bf16 v[160:163], v[104:107], v[40:43], v[160:163]
  ds_read_b64_tr_b16 v[70:71], v13 offset:14592
  ds_read_b64_tr_b16 v[72:73], v15 offset:12288
  ds_read_b64_tr_b16 v[74:75], v15 offset:12544
  s_waitcnt lgkmcnt(15)
  v_mfma_f32_16x16x32_bf16 v[164:167], a[0:3], a[0:3], v[164:167]
  ds_read_b64_tr_b16 v[76:77], v12 offset:18432
  v_mfma_f32_16x16x32_bf16 v[168:171], a[4:7], a[4:7], v[168:171]
  ds_read_b64_tr_b16 v[78:79], v12 offset:18688
  v_mfma_f32_16x16x32_bf16 v[172:175], a[16:19], a[16:19], v[172:175]
  ds_read_b64_tr_b16 v[80:81], v13 offset:18432
  v_mfma_f32_16x16x32_bf16 v[176:179], v[40:43], a[0:3], v[176:179]
  ds_read_b64_tr_b16 v[82:83], v13 offset:18688
  v_mfma_f32_16x16x32_bf16 v[180:183], v[40:43], a[4:7], v[180:183]
  ds_read_b64_tr_b16 v[84:85], v12 offset:19456
  s_waitcnt lgkmcnt(5)
  v_mfma_f32_16x16x32_bf16 v[108:111], v[48:51], a[0:3], v[108:111]
  ds_read_b64_tr_b16 v[86:87], v12 offset:19712
  v_mfma_f32_16x16x32_bf16 v[132:135], v[48:51], a[4:7], v[132:135]
  ds_read_b64_tr_b16 v[88:89], v13 offset:19456
  v_mfma_f32_16x16x32_bf16 v[112:115], v[52:55], a[0:3], v[112:115]
  ds_read_b64_tr_b16 v[90:91], v13 offset:19712
  v_mfma_f32_16x16x32_bf16 v[136:139], v[52:55], a[4:7], v[136:139]
  ds_read_b64_tr_b16 v[92:93], v12 offset:20480
  v_mfma_f32_16x16x32_bf16 v[116:119], v[56:59], a[0:3], v[116:119]
  ds_read_b64_tr_b16 v[94:95], v12 offset:20736
  v_mfma_f32_16x16x32_bf16 v[140:143], v[56:59], a[4:7], v[140:143]
  ds_read_b64_tr_b16 v[96:97], v13 offset:20480
  v_mfma_f32_16x16x32_bf16 v[120:123], v[60:63], a[0:3], v[120:123]
  ds_read_b64_tr_b16 v[98:99], v13 offset:20736
  v_mfma_f32_16x16x32_bf16 v[144:147], v[60:63], a[4:7], v[144:147]
  ds_read_b64_tr_b16 v[100:101], v15 offset:18432
  v_mfma_f32_16x16x32_bf16 v[124:127], v[64:67], a[0:3], v[124:127]
  ds_read_b64_tr_b16 v[102:103], v15 offset:18688
  v_mfma_f32_16x16x32_bf16 v[148:151], v[64:67], a[4:7], v[148:151]
  ds_read_b64_tr_b16 v[104:105], v44 offset:12288
  v_mfma_f32_16x16x32_bf16 v[128:131], v[68:71], a[0:3], v[128:131]
  ds_read_b64_tr_b16 v[106:107], v44 offset:12544
  v_mfma_f32_16x16x32_bf16 v[152:155], v[68:71], a[4:7], v[152:155]
  v_mfma_f32_16x16x32_bf16 v[156:159], v[72:75], a[16:19], v[156:159]
  v_mfma_f32_16x16x32_bf16 v[164:167], a[8:11], a[8:11], v[164:167]
  s_barrier
  v_mfma_f32_16x16x32_bf16 v[168:171], a[12:15], a[12:15], v[168:171]
  ds_read_b128 a[24:27], v21 offset:16384
  v_mfma_f32_16x16x32_bf16 v[172:175], a[20:23], a[20:23], v[172:175]
  ds_read_b128 a[28:31], v21 offset:17408
  v_mfma_f32_16x16x32_bf16 v[176:179], v[40:43], a[8:11], v[176:179]
  ds_read_b128 a[32:35], v22 offset:16384
  v_mfma_f32_16x16x32_bf16 v[180:183], v[40:43], a[12:15], v[180:183]
  ds_read_b128 a[36:39], v22 offset:17408
  s_waitcnt lgkmcnt(4)
  v_mfma_f32_16x16x32_bf16 v[108:111], v[76:79], a[8:11], v[108:111]
  s_mov_b64 exec, s[84:85]
  ds_read_b128 a[40:43], v23 offset:14336
  ds_read_b128 a[44:47], v24 offset:14336
  s_mov_b64 exec, -1
  v_mfma_f32_16x16x32_bf16 v[132:135], v[76:79], a[12:15], v[132:135]
  s_cmp_eq_u32 s60, 7
  s_cbranch_scc0 L_res7
  ds_read_b64 v[32:33], v25
  ds_read_b64 v[34:35], v26
  ds_read_b64 v[36:37], v27
  ds_read_b64 v[38:39], v28
L_res7:
  v_mfma_f32_16x16x32_bf16 v[112:115], v[80:83], a[8:11], v[112:115]
  ds_read_b64_tr_b16 v[48:49], v12 offset:24576
  v_mfma_f32_16x16x32_bf16 v[136:139], v[80:83], a[12:15], v[136:139]
  ds_read_b64_tr_b16 v[50:51], v12 offset:24832
  v_mfma_f32_16x16x32_bf16 v[116:119], v[84:87], a[8:11], v[116:119]
  ds_read_b64_tr_b16 v[52:53], v13 offset:24576
  v_mfma_f32_16x16x32_bf16 v[140:143], v[84:87], a[12:15], v[140:143]
  ds_read_b64_tr_b16 v[54:55], v13 offset:24832
  v_mfma_f32_16x16x32_bf16 v[120:123], v[88:91], a[8:11], v[120:123]
  ds_read_b64_tr_b16 v[56:57], v12 offset:25600
  v_mfma_f32_16x16x32_bf16 v[144:147], v[88:91], a[12:15], v[144:147]
  ds_read_b64_tr_b16 v[58:59], v12 offset:25856
  v_mfma_f32_16x16x32_bf16 v[124:127], v[92:95], a[8:11], v[124:127]
  ds_read_b64_tr_b16 v[60:61], v13 offset:25600
  v_mfma_f32_16x16x32_bf16 v[148:151], v[92:95], a[12:15], v[148:151]
  ds_read_b64_tr_b16 v[62:63], v13 offset:25856
  v_mfma_f32_16x16x32_bf16 v[128:131], v[96:99], a[8:11], v[128:131]
  ds_read_b64_tr_b16 v[64:65], v12 offset:26624
  v_mfma_f32_16x16x32_bf16 v[152:155], v[96:99], a[12:15], v[152:155]
  ds_read_b64_tr_b16 v[66:67], v12 offset:26880
  v_mfma_f32_16x16x32_bf16 v[156:159], v[100:103], a[20:23], v[156:159]
  ds_read_b64_tr_b16 v[68:69], v13 offset:26624
  v_mfma_f32_16x16x32_bf16 v[160:163], v[104:107], v[40:43], v[160:163]
  ds_read_b64_tr_b16 v[70:71], v13 offset:26880
  ds_read_b64_tr_b16 v[72:73], v15 offset:24576
  ds_read_b64_tr_b16 v[74:75], v15 offset:24832
  ds_read_b64_tr_b16 v[184:185], v46 offset:0
  ds_read_b64_tr_b16 v[186:187], v46 offset:3584
  s_waitcnt vmcnt(0)
  ds_read_b64_tr_b16 v[188:189], v46 offset:7296
  ds_read_b64_tr_b16 v[190:191], v46 offset:10880
  s_waitcnt lgkmcnt(15)
  v_mfma_f32_16x16x32_bf16 v[164:167], a[24:27], a[24:27], v[164:167]
  ds_read_b64_tr_b16 v[76:77], v12 offset:30720
  v_mfma_f32_16x16x32_bf16 v[168:171], a[28:31], a[28:31], v[168:171]
  ds_read_b64_tr_b16 v[78:79], v12 offset:30976
  v_mfma_f32_16x16x32_bf16 v[172:175], a[40:43], a[40:43], v[172:175]
  ds_read_b64_tr_b16 v[80:81], v13 offset:30720
  v_mfma_f32_16x16x32_bf16 v[176:179], v[40:43], a[24:27], v[176:179]
  ds_read_b64_tr_b16 v[82:83], v13 offset:30976
  v_mfma_f32_16x16x32_bf16 v[180:183], v[40:43], a[28:31], v[180:183]
  ds_read_b64_tr_b16 v[84:85], v12 offset:31744
  s_waitcnt lgkmcnt(9)
  v_mfma_f32_16x16x32_bf16 v[108:111], v[48:51], a[24:27], v[108:111]
  ds_read_b64_tr_b16 v[86:87], v12 offset:32000
  s_waitcnt lgkmcnt(8)
  v_mfma_f32_16x16x32_bf16 a[48:51], v[40:43], v[184:187], 0
  ds_read_b64_tr_b16 v[88:89], v13 offset:31744
  s_waitcnt lgkmcnt(7)
  v_mfma_f32_16x16x32_bf16 a[52:55], v[40:43], v[188:191], 0
  ds_read_b64_tr_b16 v[90:91], v13 offset:32000
  v_mfma_f32_16x16x32_bf16 v[132:135], v[48:51], a[28:31], v[132:135]
  ds_read_b64_tr_b16 v[184:185], v47 offset:0
  v_mfma_f32_16x16x32_bf16 v[112:115], v[52:55], a[24:27], v[112:115]
  ds_read_b64_tr_b16 v[186:187], v47 offset:3584
  v_mfma_f32_16x16x32_bf16 v[136:139], v[52:55], a[28:31], v[136:139]
  ds_read_b64_tr_b16 v[188:189], v47 offset:7296
  v_mfma_f32_16x16x32_bf16 v[116:119], v[56:59], a[24:27], v[116:119]
  ds_read_b64_tr_b16 v[190:191], v47 offset:10880
  v_mfma_f32_16x16x32_bf16 v[140:143], v[56:59], a[28:31], v[140:143]
  ds_read_b64_tr_b16 v[92:93], v12 offset:32768
  v_mfma_f32_16x16x32_bf16 v[120:123], v[60:63], a[24:27], v[120:123]
  ds_read_b64_tr_b16 v[94:95], v12 offset:33024
  v_mfma_f32_16x16x32_bf16 v[144:147], v[60:63], a[28:31], v[144:147]
  ds_read_b64_tr_b16 v[96:97], v13 offset:32768
  v_mfma_f32_16x16x32_bf16 v[124:127], v[64:67], a[24:27], v[124:127]
  ds_read_b64_tr_b16 v[98:99], v13 offset:33024
  v_mfma_f32_16x16x32_bf16 v[148:151], v[64:67], a[28:31], v[148:151]
  ds_read_b64_tr_b16 v[100:101], v15 offset:30720
  v_mfma_f32_16x16x32_bf16 v[128:131], v[68:71], a[24:27], v[128:131]
  ds_read_b64_tr_b16 v[102:103], v15 offset:30976
  v_mfma_f32_16x16x32_bf16 v[152:155], v[68:71], a[28:31], v[152:155]
  ds_read_b64_tr_b16 v[104:105], v44 offset:24576
  v_mfma_f32_16x16x32_bf16 v[156:159], v[72:75], a[40:43], v[156:159]
  ds_read_b64_tr_b16 v[106:107], v44 offset:24832
  s_waitcnt lgkmcnt(10)
  v_mfma_f32_16x16x32_bf16 a[56:59], v[40:43], v[184:187], 0
  s_waitcnt lgkmcnt(8)
  v_mfma_f32_16x16x32_bf16 a[60:63], v[40:43], v[188:191], 0
  v_mfma_f32_16x16x32_bf16 v[164:167], a[32:35], a[32:35], v[164:167]
  v_mfma_f32_16x16x32_bf16 v[168:171], a[36:39], a[36:39], v[168:171]
  v_mfma_f32_16x16x32_bf16 v[172:175], a[44:47], a[44:47], v[172:175]
  v_mfma_f32_16x16x32_bf16 v[176:179], v[40:43], a[32:35], v[176:179]
  v_mfma_f32_16x16x32_bf16 v[180:183], v[40:43], a[36:39], v[180:183]
  s_waitcnt lgkmcnt(0)
  v_mfma_f32_16x16x32_bf16 v[108:111], v[76:79], a[32:35], v[108:111]
  v_mfma_f32_16x16x32_bf16 v[132:135], v[76:79], a[36:39], v[132:135]
  v_accvgpr_read_b32 v184, a48
  s_mov_b32 exec_lo, 0xffff0000
  v_accvgpr_read_b32 v184, a52
  s_mov_b32 exec_lo, 0
  v_accvgpr_read_b32 v184, a56
  s_mov_b32 exec_hi, 0xffff0000
  v_accvgpr_read_b32 v184, a60
  s_mov_b64 exec, -1
  v_mfma_f32_16x16x32_bf16 v[112:115], v[80:83], a[32:35], v[112:115]
  buffer_store_dword v184, v29, s[48:51], 0 offen sc1
  v_mfma_f32_16x16x32_bf16 v[136:139], v[80:83], a[36:39], v[136:139]
  v_mfma_f32_16x16x32_bf16 v[116:119], v[84:87], a[32:35], v[116:119]
  v_mfma_f32_16x16x32_bf16 v[140:143], v[84:87], a[36:39], v[140:143]
  v_mfma_f32_16x16x32_bf16 v[120:123], v[88:91], a[32:35], v[120:123]
  v_mfma_f32_16x16x32_bf16 v[144:147], v[88:91], a[36:39], v[144:147]
  v_mfma_f32_16x16x32_bf16 v[124:127], v[92:95], a[32:35], v[124:127]
  v_mfma_f32_16x16x32_bf16 v[148:151], v[92:95], a[36:39], v[148:151]
  v_mfma_f32_16x16x32_bf16 v[128:131], v[96:99], a[32:35], v[128:131]
  v_mfma_f32_16x16x32_bf16 v[152:155], v[96:99], a[36:39], v[152:155]
  v_mfma_f32_16x16x32_bf16 v[156:159], v[100:103], a[44:47], v[156:159]
  v_mfma_f32_16x16x32_bf16 v[160:163], v[104:107], v[40:43], v[160:163]
  s_lshl_b32 s63, s58, 6
  s_add_u32 s63, s63, 32768
  v_lshl_add_u32 v17, v3, 4, s63
  v_mov_b32 v5, 32768
  v_lshl_add_u32 v18, v3, 4, v5
  v_mov_b32 v4, 0
  buffer_load_dword v20, v4, s[52:55], 0 offen sc1
  s_mov_b64 exec, s[82:83]
  ds_write_b128 v17, v[156:159]
  ds_write_b128 v17, v[160:163] offset:256
  s_mov_b64 exec, -1
  s_mov_b32 s90, 989855744
  s_mov_b32 s91, 925353388
  s_mov_b64 s[86:87], 0xffff
  v_cndmask_b32 v48, v164, v165, s[74:75]
  v_cndmask_b32 v50, v168, v169, s[74:75]
  v_cndmask_b32 v52, v172, v173, s[74:75]
  v_cndmask_b32 v54, 0, v172, s[86:87]
  v_cndmask_b32 v48, v48, v166, s[76:77]
  v_cndmask_b32 v50, v50, v170, s[76:77]
  v_cndmask_b32 v52, v52, v174, s[76:77]
  v_mov_b32 v55, v54
  v_cndmask_b32 v48, v48, v167, s[78:79]
  v_cndmask_b32 v50, v50, v171, s[78:79]
  v_cndmask_b32 v52, v52, v175, s[78:79]
  v_permlane16_swap_b32 v54, v55
  v_cndmask_b32 v48, 0, v48, s[80:81]
  v_cndmask_b32 v50, 0, v50, s[80:81]
  v_cndmask_b32 v52, 0, v52, s[80:81]
  v_add_f32 v54, v54, v55
  v_mov_b32 v49, v48
  v_mov_b32 v51, v50
  v_mov_b32 v53, v52
  v_mov_b32 v55, v54
  v_permlane16_swap_b32 v48, v49
  v_permlane16_swap_b32 v50, v51
  v_permlane16_swap_b32 v52, v53
  v_permlane32_swap_b32 v54, v55
  v_add_f32 v48, v48, v49
  v_add_f32 v50, v50, v51
  v_add_f32 v52, v52, v53
  v_add_f32 v54, v54, v55
  v_mov_b32 v49, v48
  v_mov_b32 v51, v50
  v_mov_b32 v53, v52
  v_permlane32_swap_b32 v48, v49
  v_permlane32_swap_b32 v50, v51
  v_permlane32_swap_b32 v52, v53
  v_add_f32 v48, v48, v49
  v_add_f32 v50, v50, v51
  v_add_f32 v52, v52, v53
  v_mul_f32 v184, s90, v176
  v_mul_f32 v185, s90, v180
  v_mul_f32 v186, s90, v54
  v_mul_f32 v48, s90, v48
  v_mul_f32 v50, s90, v50
  v_mul_f32 v52, s90, v52
  v_fma_f32 v48, -v184, v184, v48
  v_fma_f32 v50, -v185, v185, v50
  v_fma_f32 v52, -v186, v186, v52
  v_max_f32 v48, 0, v48
  v_max_f32 v50, 0, v50
  v_max_f32 v52, 0, v52
  v_add_f32 v48, s91, v48
  v_add_f32 v50, s91, v50
  v_add_f32 v52, s91, v52
  v_rsq_f32 v188, v48
  v_rsq_f32 v189, v50
  v_rsq_f32 v190, v52
  s_waitcnt lgkmcnt(0)
  s_barrier
  ds_read_b128 v[56:59], v18 offset:0
  ds_read_b128 v[60:63], v18 offset:64
  ds_read_b128 v[64:67], v18 offset:128
  ds_read_b128 v[68:71], v18 offset:192
  ds_read_b128 v[80:83], v17
  ds_read_b128 v[48:51], v18 offset:256
  ds_read_b128 v[52:55], v18 offset:320
  ds_read_b128 v[72:75], v18 offset:384
  ds_read_b128 v[76:79], v18 offset:448
  s_mul_i32 s63, s58, 4352
  s_add_u32 s63, s63, 67712
  v_mul_u32_u24 v4, 136, v2
  v_lshl_add_u32 v4, v3, 3, v4
  v_add_u32 v19, s63, v4
  s_lshl_b32 s63, s58, 5
  s_add_u32 s63, s63, 65536
  v_add_u32 v7, s63, v4
  s_waitcnt lgkmcnt(8)
  v_fma_f32 v116, -v184, v56, v116
  v_fma_f32 v117, -v184, v57, v117
  v_fma_f32 v118, -v184, v58, v118
  v_fma_f32 v119, -v184, v59, v119
  v_mul_f32 v116, v188, v116
  v_mul_f32 v117, v188, v117
  v_mul_f32 v118, v188, v118
  v_mul_f32 v119, v188, v119
  v_cvt_pk_bf16_f32 v164, v116, v117
  v_cvt_pk_bf16_f32 v165, v118, v119
  ds_write_b64 v19, v[164:165] offset:0
  v_fma_f32 v140, -v185, v56, v140
  v_fma_f32 v141, -v185, v57, v141
  v_fma_f32 v142, -v185, v58, v142
  v_fma_f32 v143, -v185, v59, v143
  v_mul_f32 v140, v189, v140
  v_mul_f32 v141, v189, v141
  v_mul_f32 v142, v189, v142
  v_mul_f32 v143, v189, v143
  v_cvt_pk_bf16_f32 v176, v140, v141
  v_cvt_pk_bf16_f32 v177, v142, v143
  ds_write_b64 v19, v[176:177] offset:2176
  s_waitcnt lgkmcnt(9)
  v_fma_f32 v120, -v184, v60, v120
  v_fma_f32 v121, -v184, v61, v121
  v_fma_f32 v122, -v184, v62, v122
  v_fma_f32 v123, -v184, v63, v123
  v_mul_f32 v120, v188, v120
  v_mul_f32 v121, v188, v121
  v_mul_f32 v122, v188, v122
  v_mul_f32 v123, v188, v123
  v_cvt_pk_bf16_f32 v166, v120, v121
  v_cvt_pk_bf16_f32 v167, v122, v123
  ds_write_b64 v19, v[166:167] offset:32
  v_fma_f32 v144, -v185, v60, v144
  v_fma_f32 v145, -v185, v61, v145
  v_fma_f32 v146, -v185, v62, v146
  v_fma_f32 v147, -v185, v63, v147
  v_mul_f32 v144, v189, v144
  v_mul_f32 v145, v189, v145
  v_mul_f32 v146, v189, v146
  v_mul_f32 v147, v189, v147
  v_cvt_pk_bf16_f32 v178, v144, v145
  v_cvt_pk_bf16_f32 v179, v146, v147
  ds_write_b64 v19, v[178:179] offset:2208
  s_waitcnt lgkmcnt(10)
  v_fma_f32 v124, -v184, v64, v124
  v_fma_f32 v125, -v184, v65, v125
  v_fma_f32 v126, -v184, v66, v126
  v_fma_f32 v127, -v184, v67, v127
  v_mul_f32 v124, v188, v124
  v_mul_f32 v125, v188, v125
  v_mul_f32 v126, v188, v126
  v_mul_f32 v127, v188, v127
  v_cvt_pk_bf16_f32 v168, v124, v125
  v_cvt_pk_bf16_f32 v169, v126, v127
  ds_write_b64 v19, v[168:169] offset:64
  v_fma_f32 v148, -v185, v64, v148
  v_fma_f32 v149, -v185, v65, v149
  v_fma_f32 v150, -v185, v66, v150
  v_fma_f32 v151, -v185, v67, v151
  v_mul_f32 v148, v189, v148
  v_mul_f32 v149, v189, v149
  v_mul_f32 v150, v189, v150
  v_mul_f32 v151, v189, v151
  v_cvt_pk_bf16_f32 v180, v148, v149
  v_cvt_pk_bf16_f32 v181, v150, v151
  ds_write_b64 v19, v[180:181] offset:2240
  s_waitcnt lgkmcnt(11)
  v_fma_f32 v128, -v184, v68, v128
  v_fma_f32 v129, -v184, v69, v129
  v_fma_f32 v130, -v184, v70, v130
  v_fma_f32 v131, -v184, v71, v131
  v_mul_f32 v128, v188, v128
  v_mul_f32 v129, v188, v129
  v_mul_f32 v130, v188, v130
  v_mul_f32 v131, v188, v131
  v_cvt_pk_bf16_f32 v170, v128, v129
  v_cvt_pk_bf16_f32 v171, v130, v131
  ds_write_b64 v19, v[170:171] offset:96
  v_fma_f32 v152, -v185, v68, v152
  v_fma_f32 v153, -v185, v69, v153
  v_fma_f32 v154, -v185, v70, v154
  v_fma_f32 v155, -v185, v71, v155
  v_mul_f32 v152, v189, v152
  v_mul_f32 v153, v189, v153
  v_mul_f32 v154, v189, v154
  v_mul_f32 v155, v189, v155
  v_cvt_pk_bf16_f32 v182, v152, v153
  v_cvt_pk_bf16_f32 v183, v154, v155
  ds_write_b64 v19, v[182:183] offset:2272
  s_waitcnt lgkmcnt(12)
  v_fma_f32 v156, -v186, v80, v156
  v_fma_f32 v157, -v186, v81, v157
  v_fma_f32 v158, -v186, v82, v158
  v_fma_f32 v159, -v186, v83, v159
  v_mul_f32 v156, v190, v156
  v_mul_f32 v157, v190, v157
  v_mul_f32 v158, v190, v158
  v_mul_f32 v159, v190, v159
  v_cvt_pk_bf16_f32 v84, v156, v157
  v_cvt_pk_bf16_f32 v85, v158, v159
  ds_write_b64 v7, v[84:85]
  s_waitcnt lgkmcnt(10)
  v_add_f32 v48, v48, v72
  v_add_f32 v49, v49, v73
  v_add_f32 v50, v50, v74
  v_add_f32 v51, v51, v75
  s_waitcnt lgkmcnt(9)
  v_add_f32 v52, v52, v76
  v_add_f32 v53, v53, v77
  v_add_f32 v54, v54, v78
  v_add_f32 v55, v55, v79
  v_fma_f32 v108, -v184, v48, v108
  v_fma_f32 v109, -v184, v49, v109
  v_fma_f32 v110, -v184, v50, v110
  v_fma_f32 v111, -v184, v51, v111
  v_mul_f32 v108, v188, v108
  v_mul_f32 v109, v188, v109
  v_mul_f32 v110, v188, v110
  v_mul_f32 v111, v188, v111
  v_cvt_pk_bf16_f32 v160, v108, v109
  v_cvt_pk_bf16_f32 v161, v110, v111
  v_fma_f32 v132, -v185, v48, v132
  v_fma_f32 v133, -v185, v49, v133
  v_fma_f32 v134, -v185, v50, v134
  v_fma_f32 v135, -v185, v51, v135
  v_mul_f32 v132, v189, v132
  v_mul_f32 v133, v189, v133
  v_mul_f32 v134, v189, v134
  v_mul_f32 v135, v189, v135
  v_cvt_pk_bf16_f32 v172, v132, v133
  v_cvt_pk_bf16_f32 v173, v134, v135
  v_fma_f32 v112, -v184, v52, v112
  v_fma_f32 v113, -v184, v53, v113
  v_fma_f32 v114, -v184, v54, v114
  v_fma_f32 v115, -v184, v55, v115
  v_mul_f32 v112, v188, v112
  v_mul_f32 v113, v188, v113
  v_mul_f32 v114, v188, v114
  v_mul_f32 v115, v188, v115
  v_cvt_pk_bf16_f32 v162, v112, v113
  v_cvt_pk_bf16_f32 v163, v114, v115
  v_fma_f32 v136, -v185, v52, v136
  v_fma_f32 v137, -v185, v53, v137
  v_fma_f32 v138, -v185, v54, v138
  v_fma_f32 v139, -v185, v55, v139
  v_mul_f32 v136, v189, v136
  v_mul_f32 v137, v189, v137
  v_mul_f32 v138, v189, v138
  v_mul_f32 v139, v189, v139
  v_cvt_pk_bf16_f32 v174, v136, v137
  v_cvt_pk_bf16_f32 v175, v138, v139
  s_or_b32 s63, s56, s58
  s_cmp_eq_u32 s63, 0
  s_cselect_b32 s64, -100, -9
  v_mov_b32 v5, 4048155338
  v_lshlrev_b32 v4, 2, v3
  v_sub_u32 v4, v2, v4
  v_subrev_u32 v6, 0, v4
  v_cmp_gt_u32 vcc, 8, v6
  v_cmp_ge_i32 s[86:87], s64, v6
  s_nop 0
  v_cndmask_b32 v108, v5, 0, vcc
  v_cndmask_b32 v104, v5, 0, s[86:87]
  v_subrev_u32 v6, 1, v4
  v_cmp_gt_u32 vcc, 8, v6
  v_cmp_ge_i32 s[86:87], s64, v6
  s_nop 0
  v_cndmask_b32 v109, v5, 0, vcc
  v_cndmask_b32 v105, v5, 0, s[86:87]
  v_subrev_u32 v6, 2, v4
  v_cmp_gt_u32 vcc, 8, v6
  v_cmp_ge_i32 s[86:87], s64, v6
  s_nop 0
  v_cndmask_b32 v110, v5, 0, vcc
  v_cndmask_b32 v106, v5, 0, s[86:87]
  v_subrev_u32 v6, 3, v4
  v_cmp_gt_u32 vcc, 8, v6
  v_cmp_ge_i32 s[86:87], s64, v6
  s_nop 0
  v_cndmask_b32 v111, v5, 0, vcc
  v_cndmask_b32 v107, v5, 0, s[86:87]
  s_cmp_eq_u32 s58, 0
  s_cselect_b32 s90, 7, 15
  s_mov_b32 s64, 1088
  s_cselect_b32 s91, s64, 2176
  s_mul_i32 s63, s58, 4352
  s_sub_u32 s63, s63, 2176
  s_cmp_eq_u32 s58, 0
  s_cselect_b32 s63, 0, s63
  s_add_u32 s63, s63, 65536
  v_and_b32 v4, s90, v2
  v_mul_u32_u24 v4, 136, v4
  v_lshl_add_u32 v4, v3, 3, v4
  v_add_u32 v112, s63, v4
  v_add_u32 v113, s91, v112
  v_lshrrev_b32 v4, 2, v2
  v_lshl_add_u32 v4, v3, 2, v4
  v_and_b32 v5, 3, v2
  v_lshlrev_b32 v5, 3, v5
  v_and_b32 v6, s90, v4
  v_mul_u32_u24 v6, 136, v6
  v_add3_u32 v114, v6, v5, s63
  v_add_u32 v115, s91, v114
  v_mul_u32_u24 v4, 136, v4
  s_mul_i32 s63, s58, 4352
  s_add_u32 s63, s63, 67712
  v_add3_u32 v116, v4, v5, s63
  s_waitcnt lgkmcnt(0)
  s_barrier
  ds_read_b64 v[48:49], v112 offset:0
  ds_read_b64 v[50:51], v112 offset:32
  ds_read_b64 v[52:53], v113 offset:0
  ds_read_b64 v[54:55], v113 offset:32
  ds_read_b64_tr_b16 v[56:57], v114 offset:64
  ds_read_b64_tr_b16 v[58:59], v116 offset:64
  ds_read_b64_tr_b16 v[60:61], v114 offset:96
  ds_read_b64_tr_b16 v[62:63], v116 offset:96
  ds_read_b64_tr_b16 v[64:65], v115 offset:64
  ds_read_b64_tr_b16 v[66:67], v116 offset:2240
  ds_read_b64_tr_b16 v[68:69], v115 offset:96
  ds_read_b64_tr_b16 v[70:71], v116 offset:2272
  v_mfma_f32_16x16x16_bf16 v[124:127], v[164:165], v[160:161], 0
  v_mfma_f32_16x16x16_bf16 v[132:135], v[166:167], v[162:163], 0
  v_mfma_f32_16x16x16_bf16 v[140:143], v[176:177], v[172:173], 0
  v_mfma_f32_16x16x16_bf16 v[148:151], v[178:179], v[174:175], 0
  s_waitcnt lgkmcnt(11)
  v_mfma_f32_16x16x16_bf16 v[120:123], v[48:49], v[160:161], 0
  s_waitcnt lgkmcnt(10)
  v_mfma_f32_16x16x16_bf16 v[128:131], v[50:51], v[162:163], 0
  s_waitcnt lgkmcnt(9)
  v_mfma_f32_16x16x16_bf16 v[136:139], v[52:53], v[172:173], 0
  s_waitcnt lgkmcnt(8)
  v_mfma_f32_16x16x16_bf16 v[144:147], v[54:55], v[174:175], 0
  s_mov_b32 s90, 1052289595
  v_fma_f32 v124, v124, s90, v108
  v_fma_f32 v132, v132, s90, v108
  v_fma_f32 v140, v140, s90, v108
  v_fma_f32 v148, v148, s90, v108
  v_fma_f32 v125, v125, s90, v109
  v_fma_f32 v133, v133, s90, v109
  v_fma_f32 v141, v141, s90, v109
  v_fma_f32 v149, v149, s90, v109
  v_fma_f32 v126, v126, s90, v110
  v_fma_f32 v134, v134, s90, v110
  v_fma_f32 v142, v142, s90, v110
  v_fma_f32 v150, v150, s90, v110
  v_fma_f32 v127, v127, s90, v111
  v_fma_f32 v135, v135, s90, v111
  v_fma_f32 v143, v143, s90, v111
  v_fma_f32 v151, v151, s90, v111
  v_fma_f32 v120, v120, s90, v104
  v_fma_f32 v128, v128, s90, v104
  v_fma_f32 v136, v136, s90, v104
  v_fma_f32 v144, v144, s90, v104
  v_fma_f32 v121, v121, s90, v105
  v_fma_f32 v129, v129, s90, v105
  v_fma_f32 v137, v137, s90, v105
  v_fma_f32 v145, v145, s90, v105
  v_fma_f32 v122, v122, s90, v106
  v_fma_f32 v130, v130, s90, v106
  v_fma_f32 v138, v138, s90, v106
  v_fma_f32 v146, v146, s90, v106
  v_fma_f32 v123, v123, s90, v107
  v_fma_f32 v131, v131, s90, v107
  v_fma_f32 v139, v139, s90, v107
  v_fma_f32 v147, v147, s90, v107
  v_max3_f32 v88, v120, v121, v122
  v_max3_f32 v90, v128, v129, v130
  v_max3_f32 v92, v136, v137, v138
  v_max3_f32 v94, v144, v145, v146
  v_max3_f32 v88, v88, v123, v124
  v_max3_f32 v90, v90, v131, v132
  v_max3_f32 v92, v92, v139, v140
  v_max3_f32 v94, v94, v147, v148
  v_max3_f32 v88, v88, v125, v126
  v_max3_f32 v90, v90, v133, v134
  v_max3_f32 v92, v92, v141, v142
  v_max3_f32 v94, v94, v149, v150
  v_max_f32 v88, v88, v127
  v_max_f32 v90, v90, v135
  v_max_f32 v92, v92, v143
  v_max_f32 v94, v94, v151
  v_mov_b32 v89, v88
  v_mov_b32 v91, v90
  v_mov_b32 v93, v92
  v_mov_b32 v95, v94
  v_permlane16_swap_b32 v88, v89
  v_permlane16_swap_b32 v90, v91
  v_permlane16_swap_b32 v92, v93
  v_permlane16_swap_b32 v94, v95
  v_max_f32 v88, v88, v89
  v_max_f32 v90, v90, v91
  v_max_f32 v92, v92, v93
  v_max_f32 v94, v94, v95
  v_mov_b32 v89, v88
  v_mov_b32 v91, v90
  v_mov_b32 v93, v92
  v_mov_b32 v95, v94
  v_permlane32_swap_b32 v88, v89
  v_permlane32_swap_b32 v90, v91
  v_permlane32_swap_b32 v92, v93
  v_permlane32_swap_b32 v94, v95
  v_max_f32 v88, v88, v89
  v_max_f32 v90, v90, v91
  v_max_f32 v92, v92, v93
  v_max_f32 v94, v94, v95
  v_sub_f32 v120, v120, v88
  v_sub_f32 v128, v128, v90
  v_sub_f32 v136, v136, v92
  v_sub_f32 v144, v144, v94
  v_sub_f32 v121, v121, v88
  v_sub_f32 v129, v129, v90
  v_sub_f32 v137, v137, v92
  v_sub_f32 v145, v145, v94
  v_sub_f32 v122, v122, v88
  v_sub_f32 v130, v130, v90
  v_sub_f32 v138, v138, v92
  v_sub_f32 v146, v146, v94
  v_sub_f32 v123, v123, v88
  v_sub_f32 v131, v131, v90
  v_sub_f32 v139, v139, v92
  v_sub_f32 v147, v147, v94
  v_sub_f32 v124, v124, v88
  v_sub_f32 v132, v132, v90
  v_sub_f32 v140, v140, v92
  v_sub_f32 v148, v148, v94
  v_sub_f32 v125, v125, v88
  v_sub_f32 v133, v133, v90
  v_sub_f32 v141, v141, v92
  v_sub_f32 v149, v149, v94
  v_sub_f32 v126, v126, v88
  v_sub_f32 v134, v134, v90
  v_sub_f32 v142, v142, v92
  v_sub_f32 v150, v150, v94
  v_sub_f32 v127, v127, v88
  v_sub_f32 v135, v135, v90
  v_sub_f32 v143, v143, v92
  v_sub_f32 v151, v151, v94
  v_exp_f32 v120, v120
  v_exp_f32 v128, v128
  v_exp_f32 v136, v136
  v_exp_f32 v144, v144
  v_exp_f32 v121, v121
  v_exp_f32 v129, v129
  v_exp_f32 v137, v137
  v_exp_f32 v145, v145
  v_exp_f32 v122, v122
  v_exp_f32 v130, v130
  v_exp_f32 v138, v138
  v_exp_f32 v146, v146
  v_exp_f32 v123, v123
  v_exp_f32 v131, v131
  v_exp_f32 v139, v139
  v_exp_f32 v147, v147
  v_exp_f32 v124, v124
  v_exp_f32 v132, v132
  v_exp_f32 v140, v140
  v_exp_f32 v148, v148
  v_exp_f32 v125, v125
  v_exp_f32 v133, v133
  v_exp_f32 v141, v141
  v_exp_f32 v149, v149
  v_exp_f32 v126, v126
  v_exp_f32 v134, v134
  v_exp_f32 v142, v142
  v_exp_f32 v150, v150
  v_exp_f32 v127, v127
  v_exp_f32 v135, v135
  v_exp_f32 v143, v143
  v_exp_f32 v151, v151
  v_cvt_pk_bf16_f32 v72, v120, v121
  v_cvt_pk_bf16_f32 v76, v128, v129
  v_cvt_pk_bf16_f32 v80, v136, v137
  v_cvt_pk_bf16_f32 v84, v144, v145
  v_cvt_pk_bf16_f32 v73, v122, v123
  v_cvt_pk_bf16_f32 v77, v130, v131
  v_cvt_pk_bf16_f32 v81, v138, v139
  v_cvt_pk_bf16_f32 v85, v146, v147
  v_cvt_pk_bf16_f32 v74, v124, v125
  v_cvt_pk_bf16_f32 v78, v132, v133
  v_cvt_pk_bf16_f32 v82, v140, v141
  v_cvt_pk_bf16_f32 v86, v148, v149
  v_cvt_pk_bf16_f32 v75, v126, v127
  v_cvt_pk_bf16_f32 v79, v134, v135
  v_cvt_pk_bf16_f32 v83, v142, v143
  v_cvt_pk_bf16_f32 v87, v150, v151
  v_add_f32 v88, v120, v121
  v_add_f32 v90, v128, v129
  v_add_f32 v92, v136, v137
  v_add_f32 v94, v144, v145
  v_add_f32 v88, v88, v122
  v_add_f32 v90, v90, v130
  v_add_f32 v92, v92, v138
  v_add_f32 v94, v94, v146
  v_add_f32 v88, v88, v123
  v_add_f32 v90, v90, v131
  v_add_f32 v92, v92, v139
  v_add_f32 v94, v94, v147
  v_add_f32 v88, v88, v124
  v_add_f32 v90, v90, v132
  v_add_f32 v92, v92, v140
  v_add_f32 v94, v94, v148
  v_add_f32 v88, v88, v125
  v_add_f32 v90, v90, v133
  v_add_f32 v92, v92, v141
  v_add_f32 v94, v94, v149
  v_add_f32 v88, v88, v126
  v_add_f32 v90, v90, v134
  v_add_f32 v92, v92, v142
  v_add_f32 v94, v94, v150
  v_add_f32 v88, v88, v127
  v_add_f32 v90, v90, v135
  v_add_f32 v92, v92, v143
  v_add_f32 v94, v94, v151
  s_waitcnt lgkmcnt(6)
  v_mfma_f32_16x16x32_bf16 v[120:123], v[56:59], v[72:75], 0
  s_waitcnt lgkmcnt(4)
  v_mfma_f32_16x16x32_bf16 v[128:131], v[60:63], v[76:79], 0
  s_waitcnt lgkmcnt(2)
  v_mfma_f32_16x16x32_bf16 v[136:139], v[64:67], v[80:83], 0
  s_waitcnt lgkmcnt(0)
  v_mfma_f32_16x16x32_bf16 v[144:147], v[68:71], v[84:87], 0
  v_mov_b32 v89, v88
  v_mov_b32 v91, v90
  v_mov_b32 v93, v92
  v_mov_b32 v95, v94
  v_permlane16_swap_b32 v88, v89
  v_permlane16_swap_b32 v90, v91
  v_permlane16_swap_b32 v92, v93
  v_permlane16_swap_b32 v94, v95
  v_add_f32 v88, v88, v89
  v_add_f32 v90, v90, v91
  v_add_f32 v92, v92, v93
  v_add_f32 v94, v94, v95
  v_mov_b32 v89, v88
  v_mov_b32 v91, v90
  v_mov_b32 v93, v92
  v_mov_b32 v95, v94
  v_permlane32_swap_b32 v88, v89
  v_permlane32_swap_b32 v90, v91
  v_permlane32_swap_b32 v92, v93
  v_permlane32_swap_b32 v94, v95
  v_add_f32 v88, v88, v89
  v_add_f32 v90, v90, v91
  v_add_f32 v92, v92, v93
  v_add_f32 v94, v94, v95
  v_rcp_f32 v88, v88
  v_rcp_f32 v90, v90
  v_rcp_f32 v92, v92
  v_rcp_f32 v94, v94
  s_lshl_b32 s63, s56, 3
  s_lshl_b32 s64, s58, 1
  s_add_u32 s63, s63, s64
  s_lshl_b32 s63, s63, 4
  s_add_u32 s63, s63, s57
  s_lshl_b32 s63, s63, 10
  s_add_u32 s86, s63, 1048576
  s_add_u32 s87, s63, 1064960
  v_mul_f32 v120, v120, v88
  v_mul_f32 v121, v121, v88
  v_mul_f32 v122, v122, v88
  v_mul_f32 v123, v123, v88
  v_cvt_pk_bf16_f32 v96, v120, v121
  v_cvt_pk_bf16_f32 v97, v122, v123
  v_mul_f32 v128, v128, v90
  v_mul_f32 v129, v129, v90
  v_mul_f32 v130, v130, v90
  v_mul_f32 v131, v131, v90
  v_cvt_pk_bf16_f32 v98, v128, v129
  v_cvt_pk_bf16_f32 v99, v130, v131
  buffer_store_dwordx4 v[96:99], v9, s[48:51], s86 offen sc1
  v_mul_f32 v136, v136, v92
  v_mul_f32 v137, v137, v92
  v_mul_f32 v138, v138, v92
  v_mul_f32 v139, v139, v92
  v_cvt_pk_bf16_f32 v100, v136, v137
  v_cvt_pk_bf16_f32 v101, v138, v139
  v_mul_f32 v144, v144, v94
  v_mul_f32 v145, v145, v94
  v_mul_f32 v146, v146, v94
  v_mul_f32 v147, v147, v94
  v_cvt_pk_bf16_f32 v102, v144, v145
  v_cvt_pk_bf16_f32 v103, v146, v147
  buffer_store_dwordx4 v[100:103], v9, s[48:51], s87 offen sc1
  v_lshrrev_b32 v4, 2, v2
  v_lshl_add_u32 v4, v3, 2, v4
  v_lshrrev_b32 v5, 1, v4
  v_and_b32 v5, 3, v5
  v_lshlrev_b32 v5, 5, v5
  v_lshl_add_u32 v5, v4, 7, v5
  v_and_b32 v6, 3, v2
  v_lshl_add_u32 v5, v6, 3, v5
  v_xor_b32 v44, 0, v5
  v_add_u32 v44, 98304, v44
  v_xor_b32 v45, 32, v5
  v_add_u32 v45, 98304, v45
  v_xor_b32 v46, 64, v5
  v_add_u32 v46, 98304, v46
  v_xor_b32 v47, 96, v5
  v_add_u32 v47, 98304, v47
  s_lshl_b32 s63, s62, 14
  s_add_u32 s86, s63, 1048576
  s_add_u32 s87, s63, 1052672
  s_add_u32 s88, s63, 1056768
  s_add_u32 s89, s63, 1060864
  s_and_b32 s63, s56, 3
  s_lshl_b32 s63, s63, 13
  s_lshr_b32 s65, s56, 2
  s_lshl_b32 s65, s65, 8
  s_add_u32 s63, s63, s65
  s_add_u32 s63, s63, 524288
  v_and_b32 v7, 7, v2
  v_lshl_add_u32 v7, v7, 10, s63
  v_lshrrev_b32 v8, 3, v2
  v_lshl_add_u32 v8, v8, 7, v7
  s_waitcnt vmcnt(2)
  v_readfirstlane_b32 s59, v20
  s_mov_b32 s66, 0x10000
  v_mov_b32 v4, 0
  s_nop 2
  s_cmp_lg_u32 s59, 0
  s_cbranch_scc1 L_f1_nok
L_f1_n:
  buffer_load_dword v5, v4, s[52:55], 0 offen sc1
  s_waitcnt vmcnt(0)
  v_readfirstlane_b32 s59, v5
  s_nop 3
  s_cmp_lg_u32 s59, 0
  s_cbranch_scc1 L_f1_nok
  s_sub_u32 s66, s66, 1
  s_cbranch_scc0 L_f1_n
L_f1_nok:
  s_waitcnt vmcnt(0) lgkmcnt(0)
  s_barrier
  s_cmp_lg_u32 s58, 0
  s_cbranch_scc1 L_f1_join
  s_mov_b64 exec, 0xffff
  s_mov_b32 s66, 0x10000
L_f1_p:
  buffer_load_dword v5, v8, s[48:51], 0 offen sc1
  s_waitcnt vmcnt(0)
  v_cmp_ne_u32 vcc, s59, v5
  s_nop 1
  s_cbranch_vccz L_f1_join
  s_sub_u32 s66, s66, 1
  s_cbranch_scc0 L_f1_p
L_f1_join:
  s_mov_b64 exec, -1
  s_barrier
  buffer_load_dwordx4 a[0:3], v9, s[48:51], s86 offen offset:0 sc1
  buffer_load_dwordx4 a[4:7], v9, s[48:51], s86 offen offset:1024 sc1
  buffer_load_dwordx4 a[8:11], v9, s[48:51], s86 offen offset:2048 sc1
  buffer_load_dwordx4 a[12:15], v9, s[48:51], s86 offen offset:3072 sc1
  buffer_load_dwordx4 a[16:19], v9, s[48:51], s87 offen offset:0 sc1
  buffer_load_dwordx4 a[20:23], v9, s[48:51], s87 offen offset:1024 sc1
  buffer_load_dwordx4 a[24:27], v9, s[48:51], s87 offen offset:2048 sc1
  buffer_load_dwordx4 a[28:31], v9, s[48:51], s87 offen offset:3072 sc1
  buffer_load_dwordx4 a[32:35], v9, s[48:51], s88 offen offset:0 sc1
  buffer_load_dwordx4 a[36:39], v9, s[48:51], s88 offen offset:1024 sc1
  buffer_load_dwordx4 a[40:43], v9, s[48:51], s88 offen offset:2048 sc1
  buffer_load_dwordx4 a[44:47], v9, s[48:51], s88 offen offset:3072 sc1
  buffer_load_dwordx4 a[48:51], v9, s[48:51], s89 offen offset:0 sc1
  buffer_load_dwordx4 a[52:55], v9, s[48:51], s89 offen offset:1024 sc1
  buffer_load_dwordx4 a[56:59], v9, s[48:51], s89 offen offset:2048 sc1
  buffer_load_dwordx4 a[60:63], v9, s[48:51], s89 offen offset:3072 sc1
  ds_read_b64_tr_b16 v[112:113], v44 offset:0
  ds_read_b64_tr_b16 v[114:115], v44 offset:2048
  ds_read_b64_tr_b16 v[116:117], v45 offset:0
  ds_read_b64_tr_b16 v[118:119], v45 offset:2048
  ds_read_b64_tr_b16 v[120:121], v46 offset:0
  ds_read_b64_tr_b16 v[122:123], v46 offset:2048
  ds_read_b64_tr_b16 v[124:125], v47 offset:0
  ds_read_b64_tr_b16 v[126:127], v47 offset:2048
  ds_read_b64_tr_b16 v[128:129], v44 offset:4096
  ds_read_b64_tr_b16 v[130:131], v44 offset:6144
  ds_read_b64_tr_b16 v[132:133], v45 offset:4096
  ds_read_b64_tr_b16 v[134:135], v45 offset:6144
  ds_read_b64_tr_b16 v[136:137], v46 offset:4096
  ds_read_b64_tr_b16 v[138:139], v46 offset:6144
  ds_read_b64_tr_b16 v[140:141], v47 offset:4096
  ds_read_b64_tr_b16 v[142:143], v47 offset:6144
  s_waitcnt vmcnt(15) lgkmcnt(8)
  v_mfma_f32_16x16x32_bf16 v[80:83], v[112:115], a[0:3], 0
  ds_read_b64_tr_b16 v[144:145], v44 offset:8192
  ds_read_b64_tr_b16 v[146:147], v44 offset:10240
  v_mfma_f32_16x16x32_bf16 v[84:87], v[116:119], a[0:3], 0
  ds_read_b64_tr_b16 v[148:149], v45 offset:8192
  ds_read_b64_tr_b16 v[150:151], v45 offset:10240
  v_mfma_f32_16x16x32_bf16 v[88:91], v[120:123], a[0:3], 0
  ds_read_b64_tr_b16 v[152:153], v46 offset:8192
  ds_read_b64_tr_b16 v[154:155], v46 offset:10240
  v_mfma_f32_16x16x32_bf16 v[92:95], v[124:127], a[0:3], 0
  ds_read_b64_tr_b16 v[156:157], v47 offset:8192
  ds_read_b64_tr_b16 v[158:159], v47 offset:10240
  s_waitcnt vmcnt(14) lgkmcnt(8)
  v_mfma_f32_16x16x32_bf16 v[80:83], v[128:131], a[4:7], v[80:83]
  ds_read_b64_tr_b16 v[112:113], v44 offset:12288
  ds_read_b64_tr_b16 v[114:115], v44 offset:14336
  v_mfma_f32_16x16x32_bf16 v[84:87], v[132:135], a[4:7], v[84:87]
  ds_read_b64_tr_b16 v[116:117], v45 offset:12288
  ds_read_b64_tr_b16 v[118:119], v45 offset:14336
  v_mfma_f32_16x16x32_bf16 v[88:91], v[136:139], a[4:7], v[88:91]
  ds_read_b64_tr_b16 v[120:121], v46 offset:12288
  ds_read_b64_tr_b16 v[122:123], v46 offset:14336
  v_mfma_f32_16x16x32_bf16 v[92:95], v[140:143], a[4:7], v[92:95]
  ds_read_b64_tr_b16 v[124:125], v47 offset:12288
  ds_read_b64_tr_b16 v[126:127], v47 offset:14336
  s_waitcnt vmcnt(13) lgkmcnt(8)
  v_mfma_f32_16x16x32_bf16 v[80:83], v[144:147], a[8:11], v[80:83]
  ds_read_b64_tr_b16 v[128:129], v44 offset:16384
  ds_read_b64_tr_b16 v[130:131], v44 offset:18432
  v_mfma_f32_16x16x32_bf16 v[84:87], v[148:151], a[8:11], v[84:87]
  ds_read_b64_tr_b16 v[132:133], v45 offset:16384
  ds_read_b64_tr_b16 v[134:135], v45 offset:18432
  v_mfma_f32_16x16x32_bf16 v[88:91], v[152:155], a[8:11], v[88:91]
  ds_read_b64_tr_b16 v[136:137], v46 offset:16384
  ds_read_b64_tr_b16 v[138:139], v46 offset:18432
  v_mfma_f32_16x16x32_bf16 v[92:95], v[156:159], a[8:11], v[92:95]
  ds_read_b64_tr_b16 v[140:141], v47 offset:16384
  ds_read_b64_tr_b16 v[142:143], v47 offset:18432
  s_waitcnt vmcnt(12) lgkmcnt(8)
  v_mfma_f32_16x16x32_bf16 v[80:83], v[112:115], a[12:15], v[80:83]
  ds_read_b64_tr_b16 v[144:145], v44 offset:20480
  ds_read_b64_tr_b16 v[146:147], v44 offset:22528
  v_mfma_f32_16x16x32_bf16 v[84:87], v[116:119], a[12:15], v[84:87]
  ds_read_b64_tr_b16 v[148:149], v45 offset:20480
  ds_read_b64_tr_b16 v[150:151], v45 offset:22528
  v_mfma_f32_16x16x32_bf16 v[88:91], v[120:123], a[12:15], v[88:91]
  ds_read_b64_tr_b16 v[152:153], v46 offset:20480
  ds_read_b64_tr_b16 v[154:155], v46 offset:22528
  v_mfma_f32_16x16x32_bf16 v[92:95], v[124:127], a[12:15], v[92:95]
  ds_read_b64_tr_b16 v[156:157], v47 offset:20480
  ds_read_b64_tr_b16 v[158:159], v47 offset:22528
  s_waitcnt vmcnt(11) lgkmcnt(8)
  v_mfma_f32_16x16x32_bf16 v[80:83], v[128:131], a[16:19], v[80:83]
  ds_read_b64_tr_b16 v[112:113], v44 offset:24576
  ds_read_b64_tr_b16 v[114:115], v44 offset:26624
  v_mfma_f32_16x16x32_bf16 v[84:87], v[132:135], a[16:19], v[84:87]
  ds_read_b64_tr_b16 v[116:117], v45 offset:24576
  ds_read_b64_tr_b16 v[118:119], v45 offset:26624
  v_mfma_f32_16x16x32_bf16 v[88:91], v[136:139], a[16:19], v[88:91]
  ds_read_b64_tr_b16 v[120:121], v46 offset:24576
  ds_read_b64_tr_b16 v[122:123], v46 offset:26624
  v_mfma_f32_16x16x32_bf16 v[92:95], v[140:143], a[16:19], v[92:95]
  ds_read_b64_tr_b16 v[124:125], v47 offset:24576
  ds_read_b64_tr_b16 v[126:127], v47 offset:26624
  s_waitcnt vmcnt(10) lgkmcnt(8)
  v_mfma_f32_16x16x32_bf16 v[80:83], v[144:147], a[20:23], v[80:83]
  ds_read_b64_tr_b16 v[128:129], v44 offset:28672
  ds_read_b64_tr_b16 v[130:131], v44 offset:30720
  v_mfma_f32_16x16x32_bf16 v[84:87], v[148:151], a[20:23], v[84:87]
  ds_read_b64_tr_b16 v[132:133], v45 offset:28672
  ds_read_b64_tr_b16 v[134:135], v45 offset:30720
  v_mfma_f32_16x16x32_bf16 v[88:91], v[152:155], a[20:23], v[88:91]
  ds_read_b64_tr_b16 v[136:137], v46 offset:28672
  ds_read_b64_tr_b16 v[138:139], v46 offset:30720
  v_mfma_f32_16x16x32_bf16 v[92:95], v[156:159], a[20:23], v[92:95]
  ds_read_b64_tr_b16 v[140:141], v47 offset:28672
  ds_read_b64_tr_b16 v[142:143], v47 offset:30720
  s_waitcnt vmcnt(9) lgkmcnt(8)
  v_mfma_f32_16x16x32_bf16 v[80:83], v[112:115], a[24:27], v[80:83]
  ds_read_b64_tr_b16 v[144:145], v44 offset:32768
  ds_read_b64_tr_b16 v[146:147], v44 offset:34816
  v_mfma_f32_16x16x32_bf16 v[84:87], v[116:119], a[24:27], v[84:87]
  ds_read_b64_tr_b16 v[148:149], v45 offset:32768
  ds_read_b64_tr_b16 v[150:151], v45 offset:34816
  v_mfma_f32_16x16x32_bf16 v[88:91], v[120:123], a[24:27], v[88:91]
  ds_read_b64_tr_b16 v[152:153], v46 offset:32768
  ds_read_b64_tr_b16 v[154:155], v46 offset:34816
  v_mfma_f32_16x16x32_bf16 v[92:95], v[124:127], a[24:27], v[92:95]
  ds_read_b64_tr_b16 v[156:157], v47 offset:32768
  ds_read_b64_tr_b16 v[158:159], v47 offset:34816
  s_waitcnt vmcnt(8) lgkmcnt(8)
  v_mfma_f32_16x16x32_bf16 v[80:83], v[128:131], a[28:31], v[80:83]
  ds_read_b64_tr_b16 v[112:113], v44 offset:36864
  ds_read_b64_tr_b16 v[114:115], v44 offset:38912
  v_mfma_f32_16x16x32_bf16 v[84:87], v[132:135], a[28:31], v[84:87]
  ds_read_b64_tr_b16 v[116:117], v45 offset:36864
  ds_read_b64_tr_b16 v[118:119], v45 offset:38912
  v_mfma_f32_16x16x32_bf16 v[88:91], v[136:139], a[28:31], v[88:91]
  ds_read_b64_tr_b16 v[120:121], v46 offset:36864
  ds_read_b64_tr_b16 v[122:123], v46 offset:38912
  v_mfma_f32_16x16x32_bf16 v[92:95], v[140:143], a[28:31], v[92:95]
  ds_read_b64_tr_b16 v[124:125], v47 offset:36864
  ds_read_b64_tr_b16 v[126:127], v47 offset:38912
  s_waitcnt vmcnt(7) lgkmcnt(8)
  v_mfma_f32_16x16x32_bf16 v[80:83], v[144:147], a[32:35], v[80:83]
  ds_read_b64_tr_b16 v[128:129], v44 offset:40960
  ds_read_b64_tr_b16 v[130:131], v44 offset:43008
  v_mfma_f32_16x16x32_bf16 v[84:87], v[148:151], a[32:35], v[84:87]
  ds_read_b64_tr_b16 v[132:133], v45 offset:40960
  ds_read_b64_tr_b16 v[134:135], v45 offset:43008
  v_mfma_f32_16x16x32_bf16 v[88:91], v[152:155], a[32:35], v[88:91]
  ds_read_b64_tr_b16 v[136:137], v46 offset:40960
  ds_read_b64_tr_b16 v[138:139], v46 offset:43008
  v_mfma_f32_16x16x32_bf16 v[92:95], v[156:159], a[32:35], v[92:95]
  ds_read_b64_tr_b16 v[140:141], v47 offset:40960
  ds_read_b64_tr_b16 v[142:143], v47 offset:43008
  s_waitcnt vmcnt(6) lgkmcnt(8)
  v_mfma_f32_16x16x32_bf16 v[80:83], v[112:115], a[36:39], v[80:83]
  ds_read_b64_tr_b16 v[144:145], v44 offset:45056
  ds_read_b64_tr_b16 v[146:147], v44 offset:47104
  v_mfma_f32_16x16x32_bf16 v[84:87], v[116:119], a[36:39], v[84:87]
  ds_read_b64_tr_b16 v[148:149], v45 offset:45056
  ds_read_b64_tr_b16 v[150:151], v45 offset:47104
  v_mfma_f32_16x16x32_bf16 v[88:91], v[120:123], a[36:39], v[88:91]
  ds_read_b64_tr_b16 v[152:153], v46 offset:45056
  ds_read_b64_tr_b16 v[154:155], v46 offset:47104
  v_mfma_f32_16x16x32_bf16 v[92:95], v[124:127], a[36:39], v[92:95]
  ds_read_b64_tr_b16 v[156:157], v47 offset:45056
  ds_read_b64_tr_b16 v[158:159], v47 offset:47104
  s_waitcnt vmcnt(5) lgkmcnt(8)
  v_mfma_f32_16x16x32_bf16 v[80:83], v[128:131], a[40:43], v[80:83]
  ds_read_b64_tr_b16 v[112:113], v44 offset:49152
  ds_read_b64_tr_b16 v[114:115], v44 offset:51200
  v_mfma_f32_16x16x32_bf16 v[84:87], v[132:135], a[40:43], v[84:87]
  ds_read_b64_tr_b16 v[116:117], v45 offset:49152
  ds_read_b64_tr_b16 v[118:119], v45 offset:51200
  v_mfma_f32_16x16x32_bf16 v[88:91], v[136:139], a[40:43], v[88:91]
  ds_read_b64_tr_b16 v[120:121], v46 offset:49152
  ds_read_b64_tr_b16 v[122:123], v46 offset:51200
  v_mfma_f32_16x16x32_bf16 v[92:95], v[140:143], a[40:43], v[92:95]
  ds_read_b64_tr_b16 v[124:125], v47 offset:49152
  ds_read_b64_tr_b16 v[126:127], v47 offset:51200
  s_waitcnt vmcnt(4) lgkmcnt(8)
  v_mfma_f32_16x16x32_bf16 v[80:83], v[144:147], a[44:47], v[80:83]
  ds_read_b64_tr_b16 v[128:129], v44 offset:53248
  ds_read_b64_tr_b16 v[130:131], v44 offset:55296
  v_mfma_f32_16x16x32_bf16 v[84:87], v[148:151], a[44:47], v[84:87]
  ds_read_b64_tr_b16 v[132:133], v45 offset:53248
  ds_read_b64_tr_b16 v[134:135], v45 offset:55296
  v_mfma_f32_16x16x32_bf16 v[88:91], v[152:155], a[44:47], v[88:91]
  ds_read_b64_tr_b16 v[136:137], v46 offset:53248
  ds_read_b64_tr_b16 v[138:139], v46 offset:55296
  v_mfma_f32_16x16x32_bf16 v[92:95], v[156:159], a[44:47], v[92:95]
  ds_read_b64_tr_b16 v[140:141], v47 offset:53248
  ds_read_b64_tr_b16 v[142:143], v47 offset:55296
  s_waitcnt vmcnt(3) lgkmcnt(8)
  v_mfma_f32_16x16x32_bf16 v[80:83], v[112:115], a[48:51], v[80:83]
  ds_read_b64_tr_b16 v[144:145], v44 offset:57344
  ds_read_b64_tr_b16 v[146:147], v44 offset:59392
  v_mfma_f32_16x16x32_bf16 v[84:87], v[116:119], a[48:51], v[84:87]
  ds_read_b64_tr_b16 v[148:149], v45 offset:57344
  ds_read_b64_tr_b16 v[150:151], v45 offset:59392
  v_mfma_f32_16x16x32_bf16 v[88:91], v[120:123], a[48:51], v[88:91]
  ds_read_b64_tr_b16 v[152:153], v46 offset:57344
  ds_read_b64_tr_b16 v[154:155], v46 offset:59392
  v_mfma_f32_16x16x32_bf16 v[92:95], v[124:127], a[48:51], v[92:95]
  ds_read_b64_tr_b16 v[156:157], v47 offset:57344
  ds_read_b64_tr_b16 v[158:159], v47 offset:59392
  s_waitcnt vmcnt(2) lgkmcnt(8)
  v_mfma_f32_16x16x32_bf16 v[80:83], v[128:131], a[52:55], v[80:83]
  ds_read_b64_tr_b16 v[112:113], v44 offset:61440
  ds_read_b64_tr_b16 v[114:115], v44 offset:63488
  v_mfma_f32_16x16x32_bf16 v[84:87], v[132:135], a[52:55], v[84:87]
  ds_read_b64_tr_b16 v[116:117], v45 offset:61440
  ds_read_b64_tr_b16 v[118:119], v45 offset:63488
  v_mfma_f32_16x16x32_bf16 v[88:91], v[136:139], a[52:55], v[88:91]
  ds_read_b64_tr_b16 v[120:121], v46 offset:61440
  ds_read_b64_tr_b16 v[122:123], v46 offset:63488
  v_mfma_f32_16x16x32_bf16 v[92:95], v[140:143], a[52:55], v[92:95]
  ds_read_b64_tr_b16 v[124:125], v47 offset:61440
  ds_read_b64_tr_b16 v[126:127], v47 offset:63488
  s_waitcnt vmcnt(1) lgkmcnt(8)
  v_mfma_f32_16x16x32_bf16 v[80:83], v[144:147], a[56:59], v[80:83]
  v_mfma_f32_16x16x32_bf16 v[84:87], v[148:151], a[56:59], v[84:87]
  v_mfma_f32_16x16x32_bf16 v[88:91], v[152:155], a[56:59], v[88:91]
  v_mfma_f32_16x16x32_bf16 v[92:95], v[156:159], a[56:59], v[92:95]
  s_waitcnt vmcnt(0) lgkmcnt(0)
  v_mfma_f32_16x16x32_bf16 v[80:83], v[112:115], a[60:63], v[80:83]
  v_mfma_f32_16x16x32_bf16 v[84:87], v[116:119], a[60:63], v[84:87]
  v_mfma_f32_16x16x32_bf16 v[88:91], v[120:123], a[60:63], v[88:91]
  v_mfma_f32_16x16x32_bf16 v[92:95], v[124:127], a[60:63], v[92:95]
  s_lshl_b32 s63, s62, 14
  s_lshl_b32 s64, s60, 11
  s_add_u32 s63, s63, s64
  s_add_u32 s68, s63, 3145728
  v_lshlrev_b32 v104, 16, v32
  v_and_b32 v105, s69, v32
  v_lshlrev_b32 v106, 16, v33
  v_and_b32 v107, s69, v33
  v_add_f32 v104, v104, v80
  v_add_f32 v105, v105, v81
  v_cvt_pk_bf16_f32 v96, v104, v105
  v_add_f32 v106, v106, v82
  v_add_f32 v107, v107, v83
  v_cvt_pk_bf16_f32 v97, v106, v107
  v_lshlrev_b32 v104, 16, v34
  v_and_b32 v105, s69, v34
  v_lshlrev_b32 v106, 16, v35
  v_and_b32 v107, s69, v35
  v_add_f32 v104, v104, v84
  v_add_f32 v105, v105, v85
  v_cvt_pk_bf16_f32 v98, v104, v105
  v_add_f32 v106, v106, v86
  v_add_f32 v107, v107, v87
  v_cvt_pk_bf16_f32 v99, v106, v107
  buffer_store_dwordx4 v[96:99], v9, s[48:51], s68 offen offset:0 sc1
  v_lshlrev_b32 v104, 16, v36
  v_and_b32 v105, s69, v36
  v_lshlrev_b32 v106, 16, v37
  v_and_b32 v107, s69, v37
  v_add_f32 v104, v104, v88
  v_add_f32 v105, v105, v89
  v_cvt_pk_bf16_f32 v100, v104, v105
  v_add_f32 v106, v106, v90
  v_add_f32 v107, v107, v91
  v_cvt_pk_bf16_f32 v101, v106, v107
  v_lshlrev_b32 v104, 16, v38
  v_and_b32 v105, s69, v38
  v_lshlrev_b32 v106, 16, v39
  v_and_b32 v107, s69, v39
  v_add_f32 v104, v104, v92
  v_add_f32 v105, v105, v93
  v_cvt_pk_bf16_f32 v102, v104, v105
  v_add_f32 v106, v106, v94
  v_add_f32 v107, v107, v95
  v_cvt_pk_bf16_f32 v103, v106, v107
  buffer_store_dwordx4 v[100:103], v9, s[48:51], s68 offen offset:1024 sc1
  v_lshlrev_b32 v160, 16, v96
  v_and_b32 v161, s69, v96
  v_lshlrev_b32 v162, 16, v97
  v_and_b32 v163, s69, v97
  v_lshlrev_b32 v164, 16, v98
  v_and_b32 v165, s69, v98
  v_lshlrev_b32 v166, 16, v99
  v_and_b32 v167, s69, v99
  v_lshlrev_b32 v168, 16, v100
  v_and_b32 v169, s69, v100
  v_lshlrev_b32 v170, 16, v101
  v_and_b32 v171, s69, v101
  v_lshlrev_b32 v172, 16, v102
  v_and_b32 v173, s69, v102
  v_lshlrev_b32 v174, 16, v103
  v_and_b32 v175, s69, v103
  v_add_f32 v104, v160, v161
  v_mul_f32 v105, v160, v160
  v_add_f32 v108, v162, v163
  v_mul_f32 v109, v161, v161
  v_fmac_f32 v105, v162, v162
  v_fmac_f32 v109, v163, v163
  v_add_f32 v104, v104, v164
  v_fmac_f32 v105, v164, v164
  v_add_f32 v108, v108, v165
  v_fmac_f32 v109, v165, v165
  v_add_f32 v104, v104, v166
  v_fmac_f32 v105, v166, v166
  v_add_f32 v108, v108, v167
  v_fmac_f32 v109, v167, v167
  v_add_f32 v104, v104, v168
  v_fmac_f32 v105, v168, v168
  v_add_f32 v108, v108, v169
  v_fmac_f32 v109, v169, v169
  v_add_f32 v104, v104, v170
  v_fmac_f32 v105, v170, v170
  v_add_f32 v108, v108, v171
  v_fmac_f32 v109, v171, v171
  v_add_f32 v104, v104, v172
  v_fmac_f32 v105, v172, v172
  v_add_f32 v108, v108, v173
  v_fmac_f32 v109, v173, v173
  v_add_f32 v104, v104, v174
  v_fmac_f32 v105, v174, v174
  v_add_f32 v108, v108, v175
  v_fmac_f32 v109, v175, v175
  v_add_f32 v104, v104, v108
  v_add_f32 v105, v105, v109
  v_mov_b32 v106, v104
  v_mov_b32 v107, v105
  s_nop 0
  v_permlane16_swap_b32 v104, v106
  v_permlane16_swap_b32 v105, v107
  v_add_f32 v104, v104, v106
  v_add_f32 v105, v105, v107
  v_mov_b32 v106, v104
  v_mov_b32 v107, v105
  s_nop 0
  v_permlane32_swap_b32 v104, v106
  v_permlane32_swap_b32 v105, v107
  v_add_f32 v104, v104, v106
  v_add_f32 v105, v105, v107
  s_lshl_b32 s63, s62, 10
  s_lshl_b32 s64, s60, 7
  s_add_u32 s63, s63, s64
  s_add_u32 s63, s63, 262144
  v_lshlrev_b32 v4, 3, v2
  s_mov_b64 exec, 0xffff
  buffer_store_dwordx2 v[104:105], v4, s[48:51], s63 offen sc1
  s_mov_b64 exec, -1
  v_and_b32 v4, 1, v3
  v_mul_u32_u24 v4, 7296, v4
  v_lshrrev_b32 v5, 1, v3
  v_lshrrev_b32 v6, 2, v2
  v_lshl_add_u32 v5, v5, 2, v6
  v_mul_u32_u24 v5, 224, v5
  v_and_b32 v6, 3, v2
  v_lshlrev_b32 v6, 3, v6
  v_add3_u32 v32, v4, v5, v6
  v_add_u32 v33, 28928, v32
  v_add_u32 v34, 57856, v32
  v_add_u32 v35, 86784, v32
  v_add_u32 v36, 115712, v32
  v_and_b32 v4, 1, v3
  v_lshlrev_b32 v5, 14, v4
  v_lshrrev_b32 v6, 1, v3
  v_lshl_add_u32 v5, v6, 8, v5
  v_lshl_add_u32 v37, v2, 4, v5
  v_lshlrev_b32 v5, 10, v4
  v_lshl_add_u32 v5, v2, 3, v5
  v_lshl_add_u32 v38, v6, 9, v5
  v_mul_u32_u24 v5, 57344, v4
  v_lshl_add_u32 v5, v6, 8, v5
  v_lshl_add_u32 v40, v2, 4, v5
  v_lshlrev_b32 v6, 4, v6
  v_add_u32 v41, 160512, v6
  v_lshlrev_b32 v39, 2, v0
  s_lshl_b32 s63, s100, 3
  s_lshl_b32 s64, s58, 1
  s_add_u32 s91, s63, s64
  s_lshl_b32 s63, s91, 14
  s_add_u32 s86, s63, 3145728
  s_add_u32 s87, s63, 3149824
  s_add_u32 s88, s63, 3153920
  s_add_u32 s89, s63, 3158016
  s_lshl_b32 s94, s91, 10
  s_add_u32 s94, s94, 262144
  s_mul_i32 s90, s101, 896
  s_and_b32 s63, s100, 3
  s_lshl_b32 s63, s63, 13
  s_lshr_b32 s65, s100, 2
  s_lshl_b32 s65, s65, 8
  s_add_u32 s63, s63, s65
  s_add_u32 s63, s63, 524292
  v_and_b32 v7, 7, v2
  v_lshl_add_u32 v7, v7, 10, s63
  v_lshrrev_b32 v8, 3, v2
  v_lshl_add_u32 v8, v8, 7, v7
  s_and_b32 s63, s101, 3
  s_lshl_b32 s63, s63, 10
  s_lshr_b32 s65, s101, 2
  s_lshl_b32 s65, s65, 7
  s_add_u32 s63, s63, s65
  s_add_u32 s63, s63, 524300
  v_and_b32 v7, 7, v2
  v_lshl_add_u32 v7, v7, 12, s63
  v_lshrrev_b32 v6, 3, v2
  v_lshl_add_u32 v6, v6, 9, v7
  v_and_b32 v7, 1, v3
  v_cmp_eq_u32 vcc, 1, v7
  s_nop 1
  v_cndmask_b32 v8, v8, v6, vcc
  s_waitcnt vmcnt(0) lgkmcnt(0)
  s_barrier
  s_cmp_lg_u32 s58, 0
  s_cbranch_scc1 L_f2_join
  s_mov_b64 exec, 0xffffffff
  s_mov_b32 s66, 0x10000
L_f2_p:
  buffer_load_dword v5, v8, s[48:51], 0 offen sc1
  s_waitcnt vmcnt(0)
  v_cmp_ne_u32 vcc, s59, v5
  s_nop 1
  s_cbranch_vccz L_f2_join
  s_sub_u32 s66, s66, 1
  s_cbranch_scc0 L_f2_p
L_f2_join:
  s_mov_b64 exec, -1
  s_barrier
  buffer_load_dwordx4 a[0:3], v37, s[48:51], s86 offen offset:0 sc1
  buffer_load_dwordx4 a[4:7], v37, s[48:51], s86 offen offset:512 sc1
  buffer_load_dwordx4 a[8:11], v37, s[48:51], s86 offen offset:1024 sc1
  buffer_load_dwordx4 a[12:15], v37, s[48:51], s86 offen offset:1536 sc1
  buffer_load_dwordx4 a[16:19], v37, s[48:51], s86 offen offset:2048 sc1
  buffer_load_dwordx4 a[20:23], v37, s[48:51], s86 offen offset:2560 sc1
  buffer_load_dwordx4 a[24:27], v37, s[48:51], s86 offen offset:3072 sc1
  buffer_load_dwordx4 a[28:31], v37, s[48:51], s86 offen offset:3584 sc1
  ds_read_b64_tr_b16 v[48:49], v32 offset:0
  ds_read_b64_tr_b16 v[50:51], v32 offset:3584
  ds_read_b64_tr_b16 v[52:53], v32 offset:32
  ds_read_b64_tr_b16 v[54:55], v32 offset:3616
  ds_read_b64_tr_b16 v[56:57], v32 offset:64
  ds_read_b64_tr_b16 v[58:59], v32 offset:3648
  ds_read_b64_tr_b16 v[60:61], v32 offset:96
  ds_read_b64_tr_b16 v[62:63], v32 offset:3680
  ds_read_b64_tr_b16 v[64:65], v32 offset:128
  ds_read_b64_tr_b16 v[66:67], v32 offset:3712
  ds_read_b64_tr_b16 v[68:69], v32 offset:160
  ds_read_b64_tr_b16 v[70:71], v32 offset:3744
  s_waitcnt lgkmcnt(8)
  s_waitcnt vmcnt(7)
  v_mfma_f32_32x32x16_bf16 v[80:95], v[48:51], a[0:3], 0
  ds_read_b64_tr_b16 v[72:73], v32 offset:192
  ds_read_b64_tr_b16 v[74:75], v32 offset:3776
  v_mfma_f32_32x32x16_bf16 v[96:111], v[52:55], a[0:3], 0
  ds_read_b64_tr_b16 v[76:77], v32 offset:1792
  ds_read_b64_tr_b16 v[78:79], v32 offset:5376
  buffer_load_dwordx4 a[32:35], v37, s[48:51], s87 offen offset:0 sc1
  s_waitcnt lgkmcnt(8)
  v_mfma_f32_32x32x16_bf16 v[112:127], v[56:59], a[0:3], 0
  ds_read_b64_tr_b16 v[48:49], v32 offset:1824
  ds_read_b64_tr_b16 v[50:51], v32 offset:5408
  v_mfma_f32_32x32x16_bf16 v[128:143], v[60:63], a[0:3], 0
  ds_read_b64_tr_b16 v[52:53], v32 offset:1856
  ds_read_b64_tr_b16 v[54:55], v32 offset:5440
  buffer_load_dwordx4 a[36:39], v37, s[48:51], s87 offen offset:512 sc1
  s_waitcnt lgkmcnt(8)
  v_mfma_f32_32x32x16_bf16 v[144:159], v[64:67], a[0:3], 0
  ds_read_b64_tr_b16 v[56:57], v32 offset:1888
  ds_read_b64_tr_b16 v[58:59], v32 offset:5472
  v_mfma_f32_32x32x16_bf16 v[160:175], v[68:71], a[0:3], 0
  ds_read_b64_tr_b16 v[60:61], v32 offset:1920
  ds_read_b64_tr_b16 v[62:63], v32 offset:5504
  buffer_load_dwordx4 a[40:43], v37, s[48:51], s87 offen offset:1024 sc1
  s_waitcnt lgkmcnt(8)
  v_mfma_f32_32x32x16_bf16 v[176:191], v[72:75], a[0:3], 0
  ds_read_b64_tr_b16 v[64:65], v32 offset:1952
  ds_read_b64_tr_b16 v[66:67], v32 offset:5536
  s_waitcnt vmcnt(9)
  v_mfma_f32_32x32x16_bf16 v[80:95], v[76:79], a[4:7], v[80:95]
  ds_read_b64_tr_b16 v[68:69], v32 offset:1984
  ds_read_b64_tr_b16 v[70:71], v32 offset:5568
  buffer_load_dwordx4 a[0:3], v37, s[48:51], s88 offen offset:0 sc1
  s_waitcnt lgkmcnt(8)
  v_mfma_f32_32x32x16_bf16 v[96:111], v[48:51], a[4:7], v[96:111]
  ds_read_b64_tr_b16 v[72:73], v32 offset:14464
  ds_read_b64_tr_b16 v[74:75], v32 offset:18048
  v_mfma_f32_32x32x16_bf16 v[112:127], v[52:55], a[4:7], v[112:127]
  ds_read_b64_tr_b16 v[76:77], v32 offset:14496
  ds_read_b64_tr_b16 v[78:79], v32 offset:18080
  buffer_load_dwordx4 a[44:47], v37, s[48:51], s87 offen offset:1536 sc1
  s_waitcnt lgkmcnt(8)
  v_mfma_f32_32x32x16_bf16 v[128:143], v[56:59], a[4:7], v[128:143]
  ds_read_b64_tr_b16 v[48:49], v32 offset:14528
  ds_read_b64_tr_b16 v[50:51], v32 offset:18112
  v_mfma_f32_32x32x16_bf16 v[144:159], v[60:63], a[4:7], v[144:159]
  ds_read_b64_tr_b16 v[52:53], v32 offset:14560
  ds_read_b64_tr_b16 v[54:55], v32 offset:18144
  buffer_load_dwordx4 a[48:51], v37, s[48:51], s87 offen offset:2048 sc1
  s_waitcnt lgkmcnt(8)
  v_mfma_f32_32x32x16_bf16 v[160:175], v[64:67], a[4:7], v[160:175]
  ds_read_b64_tr_b16 v[56:57], v32 offset:14592
  ds_read_b64_tr_b16 v[58:59], v32 offset:18176
  v_mfma_f32_32x32x16_bf16 v[176:191], v[68:71], a[4:7], v[176:191]
  ds_read_b64_tr_b16 v[60:61], v32 offset:14624
  ds_read_b64_tr_b16 v[62:63], v32 offset:18208
  buffer_load_dwordx4 a[52:55], v37, s[48:51], s87 offen offset:2560 sc1
  s_waitcnt lgkmcnt(8)
  s_waitcnt vmcnt(12)
  v_mfma_f32_32x32x16_bf16 v[80:95], v[72:75], a[8:11], v[80:95]
  ds_read_b64_tr_b16 v[64:65], v32 offset:14656
  ds_read_b64_tr_b16 v[66:67], v32 offset:18240
  buffer_load_dwordx4 a[4:7], v37, s[48:51], s88 offen offset:512 sc1
  v_mfma_f32_32x32x16_bf16 v[96:111], v[76:79], a[8:11], v[96:111]
  ds_read_b64_tr_b16 v[68:69], v32 offset:16256
  ds_read_b64_tr_b16 v[70:71], v32 offset:19840
  buffer_load_dwordx4 a[56:59], v37, s[48:51], s87 offen offset:3072 sc1
  s_waitcnt lgkmcnt(8)
  v_mfma_f32_32x32x16_bf16 v[112:127], v[48:51], a[8:11], v[112:127]
  ds_read_b64_tr_b16 v[72:73], v32 offset:16288
  ds_read_b64_tr_b16 v[74:75], v32 offset:19872
  v_mfma_f32_32x32x16_bf16 v[128:143], v[52:55], a[8:11], v[128:143]
  ds_read_b64_tr_b16 v[76:77], v32 offset:16320
  ds_read_b64_tr_b16 v[78:79], v32 offset:19904
  buffer_load_dwordx4 a[60:63], v37, s[48:51], s87 offen offset:3584 sc1
  s_waitcnt lgkmcnt(8)
  v_mfma_f32_32x32x16_bf16 v[144:159], v[56:59], a[8:11], v[144:159]
  ds_read_b64_tr_b16 v[48:49], v32 offset:16352
  ds_read_b64_tr_b16 v[50:51], v32 offset:19936
  v_mfma_f32_32x32x16_bf16 v[160:175], v[60:63], a[8:11], v[160:175]
  ds_read_b64_tr_b16 v[52:53], v32 offset:16384
  ds_read_b64_tr_b16 v[54:55], v32 offset:19968
  s_add_u32 s65, s90, 8192
  buffer_load_dword v10, v39, s[48:51], s65 offen sc1
  s_waitcnt lgkmcnt(8)
  v_mfma_f32_32x32x16_bf16 v[176:191], v[64:67], a[8:11], v[176:191]
  ds_read_b64_tr_b16 v[56:57], v32 offset:16416
  ds_read_b64_tr_b16 v[58:59], v32 offset:20000
  s_waitcnt vmcnt(15)
  v_mfma_f32_32x32x16_bf16 v[80:95], v[68:71], a[12:15], v[80:95]
  ds_read_b64_tr_b16 v[60:61], v32 offset:16448
  ds_read_b64_tr_b16 v[62:63], v32 offset:20032
  buffer_load_dwordx4 a[8:11], v37, s[48:51], s88 offen offset:1024 sc1
  s_waitcnt lgkmcnt(8)
  v_mfma_f32_32x32x16_bf16 v[96:111], v[72:75], a[12:15], v[96:111]
  s_barrier
  ds_read_b64_tr_b16 v[64:65], v33 offset:0
  ds_read_b64_tr_b16 v[66:67], v33 offset:3584
  v_mfma_f32_32x32x16_bf16 v[112:127], v[76:79], a[12:15], v[112:127]
  ds_read_b64_tr_b16 v[68:69], v33 offset:32
  ds_read_b64_tr_b16 v[70:71], v33 offset:3616
  s_add_u32 s65, s90, 22528
  buffer_load_dword v11, v39, s[48:51], s65 offen sc1
  s_waitcnt lgkmcnt(8)
  v_mfma_f32_32x32x16_bf16 v[128:143], v[48:51], a[12:15], v[128:143]
  ds_read_b64_tr_b16 v[72:73], v33 offset:64
  ds_read_b64_tr_b16 v[74:75], v33 offset:3648
  v_mfma_f32_32x32x16_bf16 v[144:159], v[52:55], a[12:15], v[144:159]
  ds_read_b64_tr_b16 v[76:77], v33 offset:96
  ds_read_b64_tr_b16 v[78:79], v33 offset:3680
  s_add_u32 s65, s90, 36864
  buffer_load_dword v12, v39, s[48:51], s65 offen sc1
  s_waitcnt lgkmcnt(8)
  v_mfma_f32_32x32x16_bf16 v[160:175], v[56:59], a[12:15], v[160:175]
  ds_read_b64_tr_b16 v[48:49], v33 offset:128
  ds_read_b64_tr_b16 v[50:51], v33 offset:3712
  v_mfma_f32_32x32x16_bf16 v[176:191], v[60:63], a[12:15], v[176:191]
  ds_read_b64_tr_b16 v[52:53], v33 offset:160
  ds_read_b64_tr_b16 v[54:55], v33 offset:3744
  s_add_u32 s65, s90, 51200
  buffer_load_dword v13, v39, s[48:51], s65 offen sc1
  s_waitcnt lgkmcnt(8)
  s_waitcnt vmcnt(18)
  v_mfma_f32_32x32x16_bf16 v[80:95], v[64:67], a[16:19], v[80:95]
  ds_read_b64_tr_b16 v[56:57], v33 offset:192
  ds_read_b64_tr_b16 v[58:59], v33 offset:3776
  buffer_load_dwordx4 a[12:15], v37, s[48:51], s88 offen offset:1536 sc1
  v_mfma_f32_32x32x16_bf16 v[96:111], v[68:71], a[16:19], v[96:111]
  ds_read_b64_tr_b16 v[60:61], v33 offset:1792
  ds_read_b64_tr_b16 v[62:63], v33 offset:5376
  s_add_u32 s65, s90, 65536
  buffer_load_dword v14, v39, s[48:51], s65 offen sc1
  s_waitcnt lgkmcnt(8)
  v_mfma_f32_32x32x16_bf16 v[112:127], v[72:75], a[16:19], v[112:127]
  ds_read_b64_tr_b16 v[64:65], v33 offset:1824
  ds_read_b64_tr_b16 v[66:67], v33 offset:5408
  v_mfma_f32_32x32x16_bf16 v[128:143], v[76:79], a[16:19], v[128:143]
  ds_read_b64_tr_b16 v[68:69], v33 offset:1856
  ds_read_b64_tr_b16 v[70:71], v33 offset:5440
  s_add_u32 s65, s90, 79872
  buffer_load_dword v15, v39, s[48:51], s65 offen sc1
  s_waitcnt lgkmcnt(8)
  v_mfma_f32_32x32x16_bf16 v[144:159], v[48:51], a[16:19], v[144:159]
  ds_read_b64_tr_b16 v[72:73], v33 offset:1888
  ds_read_b64_tr_b16 v[74:75], v33 offset:5472
  v_mfma_f32_32x32x16_bf16 v[160:175], v[52:55], a[16:19], v[160:175]
  ds_read_b64_tr_b16 v[76:77], v33 offset:1920
  ds_read_b64_tr_b16 v[78:79], v33 offset:5504
  s_add_u32 s65, s90, 94208
  buffer_load_dword v16, v39, s[48:51], s65 offen sc1
  s_waitcnt lgkmcnt(8)
  v_mfma_f32_32x32x16_bf16 v[176:191], v[56:59], a[16:19], v[176:191]
  ds_read_b64_tr_b16 v[48:49], v33 offset:1952
  ds_read_b64_tr_b16 v[50:51], v33 offset:5536
  s_waitcnt vmcnt(21)
  v_mfma_f32_32x32x16_bf16 v[80:95], v[60:63], a[20:23], v[80:95]
  ds_read_b64_tr_b16 v[52:53], v33 offset:1984
  ds_read_b64_tr_b16 v[54:55], v33 offset:5568
  buffer_load_dwordx4 a[16:19], v37, s[48:51], s88 offen offset:2048 sc1
  s_waitcnt lgkmcnt(8)
  v_mfma_f32_32x32x16_bf16 v[96:111], v[64:67], a[20:23], v[96:111]
  ds_read_b64_tr_b16 v[56:57], v33 offset:14464
  ds_read_b64_tr_b16 v[58:59], v33 offset:18048
  v_mfma_f32_32x32x16_bf16 v[112:127], v[68:71], a[20:23], v[112:127]
  ds_read_b64_tr_b16 v[60:61], v33 offset:14496
  ds_read_b64_tr_b16 v[62:63], v33 offset:18080
  s_add_u32 s65, s90, 108544
  buffer_load_dword v17, v39, s[48:51], s65 offen sc1
  s_waitcnt lgkmcnt(8)
  v_mfma_f32_32x32x16_bf16 v[128:143], v[72:75], a[20:23], v[128:143]
  ds_read_b64_tr_b16 v[64:65], v33 offset:14528
  ds_read_b64_tr_b16 v[66:67], v33 offset:18112
  v_mfma_f32_32x32x16_bf16 v[144:159], v[76:79], a[20:23], v[144:159]
  ds_read_b64_tr_b16 v[68:69], v33 offset:14560
  ds_read_b64_tr_b16 v[70:71], v33 offset:18144
  s_add_u32 s65, s90, 122880
  buffer_load_dword v18, v39, s[48:51], s65 offen sc1
  s_waitcnt lgkmcnt(8)
  v_mfma_f32_32x32x16_bf16 v[160:175], v[48:51], a[20:23], v[160:175]
  ds_read_b64_tr_b16 v[72:73], v33 offset:14592
  ds_read_b64_tr_b16 v[74:75], v33 offset:18176
  v_mfma_f32_32x32x16_bf16 v[176:191], v[52:55], a[20:23], v[176:191]
  ds_read_b64_tr_b16 v[76:77], v33 offset:14624
  ds_read_b64_tr_b16 v[78:79], v33 offset:18208
  s_add_u32 s65, s90, 137216
  buffer_load_dword v19, v39, s[48:51], s65 offen sc1
  s_waitcnt lgkmcnt(8)
  s_waitcnt vmcnt(24)
  v_mfma_f32_32x32x16_bf16 v[80:95], v[56:59], a[24:27], v[80:95]
  ds_read_b64_tr_b16 v[48:49], v33 offset:14656
  ds_read_b64_tr_b16 v[50:51], v33 offset:18240
  buffer_load_dwordx4 a[20:23], v37, s[48:51], s88 offen offset:2560 sc1
  v_mfma_f32_32x32x16_bf16 v[96:111], v[60:63], a[24:27], v[96:111]
  ds_read_b64_tr_b16 v[52:53], v33 offset:16256
  ds_read_b64_tr_b16 v[54:55], v33 offset:19840
  s_add_u32 s65, s90, 151552
  buffer_load_dword v20, v39, s[48:51], s65 offen sc1
  s_waitcnt lgkmcnt(8)
  v_mfma_f32_32x32x16_bf16 v[112:127], v[64:67], a[24:27], v[112:127]
  ds_read_b64_tr_b16 v[56:57], v33 offset:16288
  ds_read_b64_tr_b16 v[58:59], v33 offset:19872
  v_mfma_f32_32x32x16_bf16 v[128:143], v[68:71], a[24:27], v[128:143]
  ds_read_b64_tr_b16 v[60:61], v33 offset:16320
  ds_read_b64_tr_b16 v[62:63], v33 offset:19904
  s_add_u32 s65, s90, 165888
  buffer_load_dword v21, v39, s[48:51], s65 offen sc1
  s_waitcnt lgkmcnt(8)
  v_mfma_f32_32x32x16_bf16 v[144:159], v[72:75], a[24:27], v[144:159]
  ds_read_b64_tr_b16 v[64:65], v33 offset:16352
  ds_read_b64_tr_b16 v[66:67], v33 offset:19936
  v_mfma_f32_32x32x16_bf16 v[160:175], v[76:79], a[24:27], v[160:175]
  ds_read_b64_tr_b16 v[68:69], v33 offset:16384
  ds_read_b64_tr_b16 v[70:71], v33 offset:19968
  s_add_u32 s65, s90, 180224
  buffer_load_dword v22, v39, s[48:51], s65 offen sc1
  s_waitcnt lgkmcnt(8)
  v_mfma_f32_32x32x16_bf16 v[176:191], v[48:51], a[24:27], v[176:191]
  ds_read_b64_tr_b16 v[72:73], v33 offset:16416
  ds_read_b64_tr_b16 v[74:75], v33 offset:20000
  s_waitcnt vmcnt(27)
  v_mfma_f32_32x32x16_bf16 v[80:95], v[52:55], a[28:31], v[80:95]
  ds_read_b64_tr_b16 v[76:77], v33 offset:16448
  ds_read_b64_tr_b16 v[78:79], v33 offset:20032
  buffer_load_dwordx4 a[24:27], v37, s[48:51], s88 offen offset:3072 sc1
  s_waitcnt lgkmcnt(8)
  v_mfma_f32_32x32x16_bf16 v[96:111], v[56:59], a[28:31], v[96:111]
  s_barrier
  ds_read_b64_tr_b16 v[48:49], v34 offset:0
  ds_read_b64_tr_b16 v[50:51], v34 offset:3584
  v_mfma_f32_32x32x16_bf16 v[112:127], v[60:63], a[28:31], v[112:127]
  ds_read_b64_tr_b16 v[52:53], v34 offset:32
  ds_read_b64_tr_b16 v[54:55], v34 offset:3616
  s_add_u32 s65, s90, 194560
  buffer_load_dword v23, v39, s[48:51], s65 offen sc1
  s_waitcnt lgkmcnt(8)
  v_mfma_f32_32x32x16_bf16 v[128:143], v[64:67], a[28:31], v[128:143]
  ds_read_b64_tr_b16 v[56:57], v34 offset:64
  ds_read_b64_tr_b16 v[58:59], v34 offset:3648
  v_mfma_f32_32x32x16_bf16 v[144:159], v[68:71], a[28:31], v[144:159]
  ds_read_b64_tr_b16 v[60:61], v34 offset:96
  ds_read_b64_tr_b16 v[62:63], v34 offset:3680
  s_add_u32 s65, s90, 208896
  buffer_load_dword v24, v39, s[48:51], s65 offen sc1
  s_waitcnt lgkmcnt(8)
  v_mfma_f32_32x32x16_bf16 v[160:175], v[72:75], a[28:31], v[160:175]
  ds_read_b64_tr_b16 v[64:65], v34 offset:128
  ds_read_b64_tr_b16 v[66:67], v34 offset:3712
  v_mfma_f32_32x32x16_bf16 v[176:191], v[76:79], a[28:31], v[176:191]
  ds_read_b64_tr_b16 v[68:69], v34 offset:160
  ds_read_b64_tr_b16 v[70:71], v34 offset:3744
  s_add_u32 s65, s90, 223232
  buffer_load_dword v25, v39, s[48:51], s65 offen sc1
  s_waitcnt lgkmcnt(8)
  s_waitcnt vmcnt(30)
  v_mfma_f32_32x32x16_bf16 v[80:95], v[48:51], a[32:35], v[80:95]
  ds_read_b64_tr_b16 v[72:73], v34 offset:192
  ds_read_b64_tr_b16 v[74:75], v34 offset:3776
  buffer_load_dwordx4 a[28:31], v37, s[48:51], s88 offen offset:3584 sc1
  v_mfma_f32_32x32x16_bf16 v[96:111], v[52:55], a[32:35], v[96:111]
  ds_read_b64_tr_b16 v[76:77], v34 offset:1792
  ds_read_b64_tr_b16 v[78:79], v34 offset:5376
  s_waitcnt lgkmcnt(8)
  v_mfma_f32_32x32x16_bf16 v[112:127], v[56:59], a[32:35], v[112:127]
  ds_read_b64_tr_b16 v[48:49], v34 offset:1824
  ds_read_b64_tr_b16 v[50:51], v34 offset:5408
  v_mfma_f32_32x32x16_bf16 v[128:143], v[60:63], a[32:35], v[128:143]
  ds_read_b64_tr_b16 v[52:53], v34 offset:1856
  ds_read_b64_tr_b16 v[54:55], v34 offset:5440
  s_waitcnt lgkmcnt(8)
  v_mfma_f32_32x32x16_bf16 v[144:159], v[64:67], a[32:35], v[144:159]
  ds_read_b64_tr_b16 v[56:57], v34 offset:1888
  ds_read_b64_tr_b16 v[58:59], v34 offset:5472
  v_mfma_f32_32x32x16_bf16 v[160:175], v[68:71], a[32:35], v[160:175]
  ds_read_b64_tr_b16 v[60:61], v34 offset:1920
  ds_read_b64_tr_b16 v[62:63], v34 offset:5504
  s_waitcnt lgkmcnt(8)
  v_mfma_f32_32x32x16_bf16 v[176:191], v[72:75], a[32:35], v[176:191]
  ds_read_b64_tr_b16 v[64:65], v34 offset:1952
  ds_read_b64_tr_b16 v[66:67], v34 offset:5536
  s_waitcnt vmcnt(30)
  v_mfma_f32_32x32x16_bf16 v[80:95], v[76:79], a[36:39], v[80:95]
  ds_read_b64_tr_b16 v[68:69], v34 offset:1984
  ds_read_b64_tr_b16 v[70:71], v34 offset:5568
  buffer_load_dwordx4 a[32:35], v37, s[48:51], s89 offen offset:0 sc1
  s_waitcnt lgkmcnt(8)
  v_mfma_f32_32x32x16_bf16 v[96:111], v[48:51], a[36:39], v[96:111]
  ds_read_b64_tr_b16 v[72:73], v34 offset:14464
  ds_read_b64_tr_b16 v[74:75], v34 offset:18048
  v_mfma_f32_32x32x16_bf16 v[112:127], v[52:55], a[36:39], v[112:127]
  ds_read_b64_tr_b16 v[76:77], v34 offset:14496
  ds_read_b64_tr_b16 v[78:79], v34 offset:18080
  s_waitcnt lgkmcnt(8)
  v_mfma_f32_32x32x16_bf16 v[128:143], v[56:59], a[36:39], v[128:143]
  ds_read_b64_tr_b16 v[48:49], v34 offset:14528
  ds_read_b64_tr_b16 v[50:51], v34 offset:18112
  v_mfma_f32_32x32x16_bf16 v[144:159], v[60:63], a[36:39], v[144:159]
  ds_read_b64_tr_b16 v[52:53], v34 offset:14560
  ds_read_b64_tr_b16 v[54:55], v34 offset:18144
  s_waitcnt lgkmcnt(8)
  v_mfma_f32_32x32x16_bf16 v[160:175], v[64:67], a[36:39], v[160:175]
  ds_read_b64_tr_b16 v[56:57], v34 offset:14592
  ds_read_b64_tr_b16 v[58:59], v34 offset:18176
  v_mfma_f32_32x32x16_bf16 v[176:191], v[68:71], a[36:39], v[176:191]
  ds_read_b64_tr_b16 v[60:61], v34 offset:14624
  ds_read_b64_tr_b16 v[62:63], v34 offset:18208
  s_waitcnt lgkmcnt(8)
  s_waitcnt vmcnt(30)
  v_mfma_f32_32x32x16_bf16 v[80:95], v[72:75], a[40:43], v[80:95]
  ds_read_b64_tr_b16 v[64:65], v34 offset:14656
  ds_read_b64_tr_b16 v[66:67], v34 offset:18240
  buffer_load_dwordx4 a[36:39], v37, s[48:51], s89 offen offset:512 sc1
  v_mfma_f32_32x32x16_bf16 v[96:111], v[76:79], a[40:43], v[96:111]
  ds_read_b64_tr_b16 v[68:69], v34 offset:16256
  ds_read_b64_tr_b16 v[70:71], v34 offset:19840
  s_waitcnt lgkmcnt(8)
  v_mfma_f32_32x32x16_bf16 v[112:127], v[48:51], a[40:43], v[112:127]
  ds_read_b64_tr_b16 v[72:73], v34 offset:16288
  ds_read_b64_tr_b16 v[74:75], v34 offset:19872
  v_mfma_f32_32x32x16_bf16 v[128:143], v[52:55], a[40:43], v[128:143]
  ds_read_b64_tr_b16 v[76:77], v34 offset:16320
  ds_read_b64_tr_b16 v[78:79], v34 offset:19904
  s_waitcnt lgkmcnt(8)
  v_mfma_f32_32x32x16_bf16 v[144:159], v[56:59], a[40:43], v[144:159]
  ds_read_b64_tr_b16 v[48:49], v34 offset:16352
  ds_read_b64_tr_b16 v[50:51], v34 offset:19936
  v_mfma_f32_32x32x16_bf16 v[160:175], v[60:63], a[40:43], v[160:175]
  ds_read_b64_tr_b16 v[52:53], v34 offset:16384
  ds_read_b64_tr_b16 v[54:55], v34 offset:19968
  s_waitcnt lgkmcnt(8)
  v_mfma_f32_32x32x16_bf16 v[176:191], v[64:67], a[40:43], v[176:191]
  ds_read_b64_tr_b16 v[56:57], v34 offset:16416
  ds_read_b64_tr_b16 v[58:59], v34 offset:20000
  s_waitcnt vmcnt(29)
  v_mfma_f32_32x32x16_bf16 v[80:95], v[68:71], a[44:47], v[80:95]
  ds_read_b64_tr_b16 v[60:61], v34 offset:16448
  ds_read_b64_tr_b16 v[62:63], v34 offset:20032
  buffer_load_dwordx4 a[40:43], v37, s[48:51], s89 offen offset:1024 sc1
  s_waitcnt lgkmcnt(8)
  v_mfma_f32_32x32x16_bf16 v[96:111], v[72:75], a[44:47], v[96:111]
  s_barrier
  ds_read_b64_tr_b16 v[64:65], v35 offset:0
  ds_read_b64_tr_b16 v[66:67], v35 offset:3584
  v_mfma_f32_32x32x16_bf16 v[112:127], v[76:79], a[44:47], v[112:127]
  ds_read_b64_tr_b16 v[68:69], v35 offset:32
  ds_read_b64_tr_b16 v[70:71], v35 offset:3616
  s_waitcnt lgkmcnt(8)
  v_mfma_f32_32x32x16_bf16 v[128:143], v[48:51], a[44:47], v[128:143]
  ds_read_b64_tr_b16 v[72:73], v35 offset:64
  ds_read_b64_tr_b16 v[74:75], v35 offset:3648
  v_mfma_f32_32x32x16_bf16 v[144:159], v[52:55], a[44:47], v[144:159]
  ds_read_b64_tr_b16 v[76:77], v35 offset:96
  ds_read_b64_tr_b16 v[78:79], v35 offset:3680
  s_waitcnt lgkmcnt(8)
  v_mfma_f32_32x32x16_bf16 v[160:175], v[56:59], a[44:47], v[160:175]
  ds_read_b64_tr_b16 v[48:49], v35 offset:128
  ds_read_b64_tr_b16 v[50:51], v35 offset:3712
  v_mfma_f32_32x32x16_bf16 v[176:191], v[60:63], a[44:47], v[176:191]
  ds_read_b64_tr_b16 v[52:53], v35 offset:160
  ds_read_b64_tr_b16 v[54:55], v35 offset:3744
  s_waitcnt lgkmcnt(8)
  s_waitcnt vmcnt(29)
  v_mfma_f32_32x32x16_bf16 v[80:95], v[64:67], a[48:51], v[80:95]
  ds_read_b64_tr_b16 v[56:57], v35 offset:192
  ds_read_b64_tr_b16 v[58:59], v35 offset:3776
  buffer_load_dwordx4 a[44:47], v37, s[48:51], s89 offen offset:1536 sc1
  v_mfma_f32_32x32x16_bf16 v[96:111], v[68:71], a[48:51], v[96:111]
  ds_read_b64_tr_b16 v[60:61], v35 offset:1792
  ds_read_b64_tr_b16 v[62:63], v35 offset:5376
  s_waitcnt lgkmcnt(8)
  v_mfma_f32_32x32x16_bf16 v[112:127], v[72:75], a[48:51], v[112:127]
  ds_read_b64_tr_b16 v[64:65], v35 offset:1824
  ds_read_b64_tr_b16 v[66:67], v35 offset:5408
  v_mfma_f32_32x32x16_bf16 v[128:143], v[76:79], a[48:51], v[128:143]
  ds_read_b64_tr_b16 v[68:69], v35 offset:1856
  ds_read_b64_tr_b16 v[70:71], v35 offset:5440
  s_waitcnt lgkmcnt(8)
  v_mfma_f32_32x32x16_bf16 v[144:159], v[48:51], a[48:51], v[144:159]
  ds_read_b64_tr_b16 v[72:73], v35 offset:1888
  ds_read_b64_tr_b16 v[74:75], v35 offset:5472
  v_mfma_f32_32x32x16_bf16 v[160:175], v[52:55], a[48:51], v[160:175]
  ds_read_b64_tr_b16 v[76:77], v35 offset:1920
  ds_read_b64_tr_b16 v[78:79], v35 offset:5504
  s_waitcnt lgkmcnt(8)
  v_mfma_f32_32x32x16_bf16 v[176:191], v[56:59], a[48:51], v[176:191]
  ds_read_b64_tr_b16 v[48:49], v35 offset:1952
  ds_read_b64_tr_b16 v[50:51], v35 offset:5536
  s_waitcnt vmcnt(23)
  v_add_f32 v10, v10, v11
  s_waitcnt vmcnt(22)
  v_add_f32 v10, v10, v12
  v_mfma_f32_32x32x16_bf16 v[80:95], v[60:63], a[52:55], v[80:95]
  ds_read_b64_tr_b16 v[52:53], v35 offset:1984
  ds_read_b64_tr_b16 v[54:55], v35 offset:5568
  buffer_load_dwordx4 a[48:51], v37, s[48:51], s89 offen offset:2048 sc1
  s_waitcnt vmcnt(22)
  v_add_f32 v10, v10, v13
  s_waitcnt vmcnt(20)
  v_add_f32 v10, v10, v14
  s_waitcnt lgkmcnt(8)
  v_mfma_f32_32x32x16_bf16 v[96:111], v[64:67], a[52:55], v[96:111]
  ds_read_b64_tr_b16 v[56:57], v35 offset:14464
  ds_read_b64_tr_b16 v[58:59], v35 offset:18048
  s_waitcnt vmcnt(19)
  v_add_f32 v10, v10, v15
  s_waitcnt vmcnt(18)
  v_add_f32 v10, v10, v16
  v_mfma_f32_32x32x16_bf16 v[112:127], v[68:71], a[52:55], v[112:127]
  ds_read_b64_tr_b16 v[60:61], v35 offset:14496
  ds_read_b64_tr_b16 v[62:63], v35 offset:18080
  s_waitcnt vmcnt(16)
  v_add_f32 v10, v10, v17
  s_waitcnt vmcnt(15)
  v_add_f32 v10, v10, v18
  s_waitcnt lgkmcnt(8)
  v_mfma_f32_32x32x16_bf16 v[128:143], v[72:75], a[52:55], v[128:143]
  ds_read_b64_tr_b16 v[64:65], v35 offset:14528
  ds_read_b64_tr_b16 v[66:67], v35 offset:18112
  s_waitcnt vmcnt(14)
  v_add_f32 v10, v10, v19
  s_waitcnt vmcnt(12)
  v_add_f32 v10, v10, v20
  v_mfma_f32_32x32x16_bf16 v[144:159], v[76:79], a[52:55], v[144:159]
  ds_read_b64_tr_b16 v[68:69], v35 offset:14560
  ds_read_b64_tr_b16 v[70:71], v35 offset:18144
  s_waitcnt vmcnt(11)
  v_add_f32 v10, v10, v21
  s_waitcnt vmcnt(10)
  v_add_f32 v10, v10, v22
  s_waitcnt lgkmcnt(8)
  v_mfma_f32_32x32x16_bf16 v[160:175], v[48:51], a[52:55], v[160:175]
  ds_read_b64_tr_b16 v[72:73], v35 offset:14592
  ds_read_b64_tr_b16 v[74:75], v35 offset:18176
  s_waitcnt vmcnt(8)
  v_add_f32 v10, v10, v23
  s_waitcnt vmcnt(7)
  v_add_f32 v10, v10, v24
  v_mfma_f32_32x32x16_bf16 v[176:191], v[52:55], a[52:55], v[176:191]
  ds_read_b64_tr_b16 v[76:77], v35 offset:14624
  ds_read_b64_tr_b16 v[78:79], v35 offset:18208
  s_waitcnt vmcnt(6)
  v_add_f32 v10, v10, v25
  v_cmp_le_u32 vcc, 112, v0
  s_waitcnt lgkmcnt(8)
  v_mfma_f32_32x32x16_bf16 v[80:95], v[56:59], a[56:59], v[80:95]
  ds_read_b64_tr_b16 v[48:49], v35 offset:14656
  ds_read_b64_tr_b16 v[50:51], v35 offset:18240
  buffer_load_dwordx4 a[52:55], v37, s[48:51], s89 offen offset:2560 sc1
  v_mov_b32 v5, 112
  v_cndmask_b32 v5, 0, v5, vcc
  v_mfma_f32_32x32x16_bf16 v[96:111], v[60:63], a[56:59], v[96:111]
  ds_read_b64_tr_b16 v[52:53], v35 offset:16256
  ds_read_b64_tr_b16 v[54:55], v35 offset:19840
  v_sub_u32 v5, v0, v5
  v_cndmask_b32 v4, 0, 64, vcc
  s_waitcnt lgkmcnt(8)
  v_mfma_f32_32x32x16_bf16 v[112:127], v[64:67], a[56:59], v[112:127]
  ds_read_b64_tr_b16 v[56:57], v35 offset:16288
  ds_read_b64_tr_b16 v[58:59], v35 offset:19872
  v_lshrrev_b32 v6, 4, v5
  v_lshl_add_u32 v4, v6, 7, v4
  v_mfma_f32_32x32x16_bf16 v[128:143], v[68:71], a[56:59], v[128:143]
  ds_read_b64_tr_b16 v[60:61], v35 offset:16320
  ds_read_b64_tr_b16 v[62:63], v35 offset:19904
  v_and_b32 v5, 15, v5
  v_lshl_add_u32 v4, v5, 2, v4
  s_waitcnt lgkmcnt(8)
  v_mfma_f32_32x32x16_bf16 v[144:159], v[72:75], a[56:59], v[144:159]
  ds_read_b64_tr_b16 v[64:65], v35 offset:16352
  ds_read_b64_tr_b16 v[66:67], v35 offset:19936
  v_add_u32 v4, 160512, v4
  ds_write_b32 v4, v10
  v_mfma_f32_32x32x16_bf16 v[160:175], v[76:79], a[56:59], v[160:175]
  ds_read_b64_tr_b16 v[68:69], v35 offset:16384
  ds_read_b64_tr_b16 v[70:71], v35 offset:19968
  buffer_load_dwordx2 v[12:13], v38, s[48:51], s94 offen offset:0 sc1
  buffer_load_dwordx2 v[14:15], v38, s[48:51], s94 offen offset:128 sc1
  s_waitcnt lgkmcnt(9)
  v_mfma_f32_32x32x16_bf16 v[176:191], v[48:51], a[56:59], v[176:191]
  ds_read_b64_tr_b16 v[72:73], v35 offset:16416
  ds_read_b64_tr_b16 v[74:75], v35 offset:20000
  buffer_load_dwordx2 v[16:17], v38, s[48:51], s94 offen offset:256 sc1
  buffer_load_dwordx2 v[18:19], v38, s[48:51], s94 offen offset:384 sc1
  v_mfma_f32_32x32x16_bf16 v[80:95], v[52:55], a[60:63], v[80:95]
  ds_read_b64_tr_b16 v[76:77], v35 offset:16448
  ds_read_b64_tr_b16 v[78:79], v35 offset:20032
  buffer_load_dwordx4 a[56:59], v37, s[48:51], s89 offen offset:3072 sc1
  s_waitcnt lgkmcnt(9)
  v_mfma_f32_32x32x16_bf16 v[96:111], v[56:59], a[60:63], v[96:111]
  s_barrier
  ds_read_b64_tr_b16 v[48:49], v36 offset:0
  ds_read_b64_tr_b16 v[50:51], v36 offset:3584
  v_mfma_f32_32x32x16_bf16 v[112:127], v[60:63], a[60:63], v[112:127]
  ds_read_b64_tr_b16 v[52:53], v36 offset:32
  ds_read_b64_tr_b16 v[54:55], v36 offset:3616
  s_waitcnt lgkmcnt(8)
  v_mfma_f32_32x32x16_bf16 v[128:143], v[64:67], a[60:63], v[128:143]
  ds_read_b64_tr_b16 v[56:57], v36 offset:64
  ds_read_b64_tr_b16 v[58:59], v36 offset:3648
  v_mfma_f32_32x32x16_bf16 v[144:159], v[68:71], a[60:63], v[144:159]
  ds_read_b64_tr_b16 v[60:61], v36 offset:96
  ds_read_b64_tr_b16 v[62:63], v36 offset:3680
  s_waitcnt lgkmcnt(8)
  v_mfma_f32_32x32x16_bf16 v[160:175], v[72:75], a[60:63], v[160:175]
  ds_read_b64_tr_b16 v[64:65], v36 offset:128
  ds_read_b64_tr_b16 v[66:67], v36 offset:3712
  v_mfma_f32_32x32x16_bf16 v[176:191], v[76:79], a[60:63], v[176:191]
  ds_read_b64_tr_b16 v[68:69], v36 offset:160
  ds_read_b64_tr_b16 v[70:71], v36 offset:3744
  s_waitcnt lgkmcnt(8)
  v_mfma_f32_32x32x16_bf16 v[80:95], v[48:51], a[0:3], v[80:95]
  ds_read_b64_tr_b16 v[72:73], v36 offset:192
  ds_read_b64_tr_b16 v[74:75], v36 offset:3776
  buffer_load_dwordx4 a[60:63], v37, s[48:51], s89 offen offset:3584 sc1
  v_mfma_f32_32x32x16_bf16 v[96:111], v[52:55], a[0:3], v[96:111]
  ds_read_b64_tr_b16 v[76:77], v36 offset:1792
  ds_read_b64_tr_b16 v[78:79], v36 offset:5376
  s_waitcnt lgkmcnt(8)
  v_mfma_f32_32x32x16_bf16 v[112:127], v[56:59], a[0:3], v[112:127]
  ds_read_b64_tr_b16 v[48:49], v36 offset:1824
  ds_read_b64_tr_b16 v[50:51], v36 offset:5408
  v_mfma_f32_32x32x16_bf16 v[128:143], v[60:63], a[0:3], v[128:143]
  ds_read_b64_tr_b16 v[52:53], v36 offset:1856
  ds_read_b64_tr_b16 v[54:55], v36 offset:5440
  s_waitcnt lgkmcnt(8)
  v_mfma_f32_32x32x16_bf16 v[144:159], v[64:67], a[0:3], v[144:159]
  ds_read_b64_tr_b16 v[56:57], v36 offset:1888
  ds_read_b64_tr_b16 v[58:59], v36 offset:5472
  v_mfma_f32_32x32x16_bf16 v[160:175], v[68:71], a[0:3], v[160:175]
  ds_read_b64_tr_b16 v[60:61], v36 offset:1920
  ds_read_b64_tr_b16 v[62:63], v36 offset:5504
  s_waitcnt lgkmcnt(8)
  v_mfma_f32_32x32x16_bf16 v[176:191], v[72:75], a[0:3], v[176:191]
  ds_read_b64_tr_b16 v[64:65], v36 offset:1952
  ds_read_b64_tr_b16 v[66:67], v36 offset:5536
  v_mfma_f32_32x32x16_bf16 v[80:95], v[76:79], a[4:7], v[80:95]
  ds_read_b64_tr_b16 v[68:69], v36 offset:1984
  ds_read_b64_tr_b16 v[70:71], v36 offset:5568
  s_waitcnt lgkmcnt(8)
  v_mfma_f32_32x32x16_bf16 v[96:111], v[48:51], a[4:7], v[96:111]
  ds_read_b64_tr_b16 v[72:73], v36 offset:14464
  ds_read_b64_tr_b16 v[74:75], v36 offset:18048
  v_mfma_f32_32x32x16_bf16 v[112:127], v[52:55], a[4:7], v[112:127]
  ds_read_b64_tr_b16 v[76:77], v36 offset:14496
  ds_read_b64_tr_b16 v[78:79], v36 offset:18080
  s_waitcnt lgkmcnt(8)
  v_mfma_f32_32x32x16_bf16 v[128:143], v[56:59], a[4:7], v[128:143]
  ds_read_b64_tr_b16 v[48:49], v36 offset:14528
  ds_read_b64_tr_b16 v[50:51], v36 offset:18112
  v_mfma_f32_32x32x16_bf16 v[144:159], v[60:63], a[4:7], v[144:159]
  ds_read_b64_tr_b16 v[52:53], v36 offset:14560
  ds_read_b64_tr_b16 v[54:55], v36 offset:18144
  s_waitcnt lgkmcnt(8)
  v_mfma_f32_32x32x16_bf16 v[160:175], v[64:67], a[4:7], v[160:175]
  ds_read_b64_tr_b16 v[56:57], v36 offset:14592
  ds_read_b64_tr_b16 v[58:59], v36 offset:18176
  v_mfma_f32_32x32x16_bf16 v[176:191], v[68:71], a[4:7], v[176:191]
  ds_read_b64_tr_b16 v[60:61], v36 offset:14624
  ds_read_b64_tr_b16 v[62:63], v36 offset:18208
  s_waitcnt lgkmcnt(8)
  v_mfma_f32_32x32x16_bf16 v[80:95], v[72:75], a[8:11], v[80:95]
  ds_read_b64_tr_b16 v[64:65], v36 offset:14656
  ds_read_b64_tr_b16 v[66:67], v36 offset:18240
  v_mfma_f32_32x32x16_bf16 v[96:111], v[76:79], a[8:11], v[96:111]
  ds_read_b64_tr_b16 v[68:69], v36 offset:16256
  ds_read_b64_tr_b16 v[70:71], v36 offset:19840
  s_waitcnt lgkmcnt(8)
  v_mfma_f32_32x32x16_bf16 v[112:127], v[48:51], a[8:11], v[112:127]
  ds_read_b64_tr_b16 v[72:73], v36 offset:16288
  ds_read_b64_tr_b16 v[74:75], v36 offset:19872
  v_mfma_f32_32x32x16_bf16 v[128:143], v[52:55], a[8:11], v[128:143]
  ds_read_b64_tr_b16 v[76:77], v36 offset:16320
  ds_read_b64_tr_b16 v[78:79], v36 offset:19904
  s_waitcnt lgkmcnt(8)
  v_mfma_f32_32x32x16_bf16 v[144:159], v[56:59], a[8:11], v[144:159]
  ds_read_b64_tr_b16 v[48:49], v36 offset:16352
  ds_read_b64_tr_b16 v[50:51], v36 offset:19936
  v_mfma_f32_32x32x16_bf16 v[160:175], v[60:63], a[8:11], v[160:175]
  ds_read_b64_tr_b16 v[52:53], v36 offset:16384
  ds_read_b64_tr_b16 v[54:55], v36 offset:19968
  s_waitcnt lgkmcnt(8)
  v_mfma_f32_32x32x16_bf16 v[176:191], v[64:67], a[8:11], v[176:191]
  ds_read_b64_tr_b16 v[56:57], v36 offset:16416
  ds_read_b64_tr_b16 v[58:59], v36 offset:20000
  v_mfma_f32_32x32x16_bf16 v[80:95], v[68:71], a[12:15], v[80:95]
  ds_read_b64_tr_b16 v[60:61], v36 offset:16448
  ds_read_b64_tr_b16 v[62:63], v36 offset:20032
  s_waitcnt lgkmcnt(8)
  v_mfma_f32_32x32x16_bf16 v[96:111], v[72:75], a[12:15], v[96:111]
  s_barrier
  ds_read_b64_tr_b16 v[64:65], v32 offset:0
  ds_read_b64_tr_b16 v[66:67], v32 offset:3584
  v_mfma_f32_32x32x16_bf16 v[112:127], v[76:79], a[12:15], v[112:127]
  ds_read_b64_tr_b16 v[68:69], v32 offset:32
  ds_read_b64_tr_b16 v[70:71], v32 offset:3616
  s_waitcnt lgkmcnt(8)
  v_mfma_f32_32x32x16_bf16 v[128:143], v[48:51], a[12:15], v[128:143]
  ds_read_b64_tr_b16 v[72:73], v32 offset:64
  ds_read_b64_tr_b16 v[74:75], v32 offset:3648
  v_mfma_f32_32x32x16_bf16 v[144:159], v[52:55], a[12:15], v[144:159]
  ds_read_b64_tr_b16 v[76:77], v32 offset:96
  ds_read_b64_tr_b16 v[78:79], v32 offset:3680
  s_waitcnt lgkmcnt(8)
  v_mfma_f32_32x32x16_bf16 v[160:175], v[56:59], a[12:15], v[160:175]
  ds_read_b64_tr_b16 v[48:49], v32 offset:128
  ds_read_b64_tr_b16 v[50:51], v32 offset:3712
  v_mfma_f32_32x32x16_bf16 v[176:191], v[60:63], a[12:15], v[176:191]
  ds_read_b64_tr_b16 v[52:53], v32 offset:160
  ds_read_b64_tr_b16 v[54:55], v32 offset:3744
  s_waitcnt lgkmcnt(8)
  v_mfma_f32_32x32x16_bf16 v[80:95], v[64:67], a[16:19], v[80:95]
  ds_read_b64_tr_b16 v[56:57], v32 offset:192
  ds_read_b64_tr_b16 v[58:59], v32 offset:3776
  s_waitcnt vmcnt(4)
  v_add_f32 v12, v12, v14
  v_add_f32 v13, v13, v15
  v_mfma_f32_32x32x16_bf16 v[96:111], v[68:71], a[16:19], v[96:111]
  ds_read_b64_tr_b16 v[60:61], v32 offset:1792
  ds_read_b64_tr_b16 v[62:63], v32 offset:5376
  s_waitcnt vmcnt(2)
  v_add_f32 v16, v16, v18
  v_add_f32 v17, v17, v19
  s_waitcnt lgkmcnt(8)
  v_mfma_f32_32x32x16_bf16 v[112:127], v[72:75], a[16:19], v[112:127]
  ds_read_b64_tr_b16 v[64:65], v32 offset:1824
  ds_read_b64_tr_b16 v[66:67], v32 offset:5408
  v_add_f32 v12, v12, v16
  v_add_f32 v13, v13, v17
  v_mfma_f32_32x32x16_bf16 v[128:143], v[76:79], a[16:19], v[128:143]
  ds_read_b64_tr_b16 v[68:69], v32 offset:1856
  ds_read_b64_tr_b16 v[70:71], v32 offset:5440
  v_mov_b32 v14, v12
  v_mov_b32 v15, v13
  s_waitcnt lgkmcnt(8)
  v_mfma_f32_32x32x16_bf16 v[144:159], v[48:51], a[16:19], v[144:159]
  ds_read_b64_tr_b16 v[72:73], v32 offset:1888
  ds_read_b64_tr_b16 v[74:75], v32 offset:5472
  v_permlane32_swap_b32 v12, v14
  v_permlane32_swap_b32 v13, v15
  v_mfma_f32_32x32x16_bf16 v[160:175], v[52:55], a[16:19], v[160:175]
  ds_read_b64_tr_b16 v[76:77], v32 offset:1920
  ds_read_b64_tr_b16 v[78:79], v32 offset:5504
  v_add_f32 v12, v12, v14
  v_add_f32 v13, v13, v15
  s_waitcnt lgkmcnt(8)
  v_mfma_f32_32x32x16_bf16 v[176:191], v[56:59], a[16:19], v[176:191]
  ds_read_b64_tr_b16 v[48:49], v32 offset:1952
  ds_read_b64_tr_b16 v[50:51], v32 offset:5536
  s_mov_b32 s95, 989855744
  s_mov_b32 s63, 925353388
  v_mfma_f32_32x32x16_bf16 v[80:95], v[60:63], a[20:23], v[80:95]
  ds_read_b64_tr_b16 v[52:53], v32 offset:1984
  ds_read_b64_tr_b16 v[54:55], v32 offset:5568
  v_mul_f32 v42, s95, v12
  v_mul_f32 v13, s95, v13
  s_waitcnt lgkmcnt(8)
  v_mfma_f32_32x32x16_bf16 v[96:111], v[64:67], a[20:23], v[96:111]
  ds_read_b64_tr_b16 v[56:57], v32 offset:14464
  ds_read_b64_tr_b16 v[58:59], v32 offset:18048
  v_fma_f32 v13, -v42, v42, v13
  v_max_f32 v13, 0, v13
  v_mfma_f32_32x32x16_bf16 v[112:127], v[68:71], a[20:23], v[112:127]
  ds_read_b64_tr_b16 v[60:61], v32 offset:14496
  ds_read_b64_tr_b16 v[62:63], v32 offset:18080
  v_add_f32 v13, s63, v13
  v_rsq_f32 v14, v13
  s_waitcnt lgkmcnt(8)
  v_mfma_f32_32x32x16_bf16 v[128:143], v[72:75], a[20:23], v[128:143]
  ds_read_b64_tr_b16 v[64:65], v32 offset:14528
  ds_read_b64_tr_b16 v[66:67], v32 offset:18112
  v_sqrt_f32 v15, v13
  v_mul_f32 v44, 3216550459, v14
  v_mfma_f32_32x32x16_bf16 v[144:159], v[76:79], a[20:23], v[144:159]
  ds_read_b64_tr_b16 v[68:69], v32 offset:14560
  ds_read_b64_tr_b16 v[70:71], v32 offset:18144
  v_mul_f32 v46, 3216550459, v15
  v_sub_f32 v42, 0, v42
  s_waitcnt lgkmcnt(8)
  v_mfma_f32_32x32x16_bf16 v[160:175], v[48:51], a[20:23], v[160:175]
  ds_read_b64_tr_b16 v[72:73], v32 offset:14592
  ds_read_b64_tr_b16 v[74:75], v32 offset:18176
  s_mul_i32 s63, s91, 57344
  s_add_u32 s90, s63, 5242880
  v_mfma_f32_32x32x16_bf16 v[176:191], v[52:55], a[20:23], v[176:191]
  ds_read_b64_tr_b16 v[76:77], v32 offset:14624
  ds_read_b64_tr_b16 v[78:79], v32 offset:18208
  s_mul_i32 s63, s101, 3584
  s_add_u32 s90, s90, s63
  s_waitcnt lgkmcnt(8)
  v_mfma_f32_32x32x16_bf16 v[80:95], v[56:59], a[24:27], v[80:95]
  ds_read_b64_tr_b16 v[48:49], v32 offset:14656
  ds_read_b64_tr_b16 v[50:51], v32 offset:18240
  ds_read_b128 v[12:15], v41 offset:0
  ds_read_b128 v[16:19], v41 offset:32
  v_mfma_f32_32x32x16_bf16 v[96:111], v[60:63], a[24:27], v[96:111]
  ds_read_b64_tr_b16 v[52:53], v32 offset:16256
  ds_read_b64_tr_b16 v[54:55], v32 offset:19840
  ds_read_b128 v[20:23], v41 offset:64
  ds_read_b128 v[24:27], v41 offset:96
  s_waitcnt lgkmcnt(12)
  v_mfma_f32_32x32x16_bf16 v[112:127], v[64:67], a[24:27], v[112:127]
  ds_read_b64_tr_b16 v[56:57], v32 offset:16288
  ds_read_b64_tr_b16 v[58:59], v32 offset:19872
  v_mfma_f32_32x32x16_bf16 v[128:143], v[68:71], a[24:27], v[128:143]
  ds_read_b64_tr_b16 v[60:61], v32 offset:16320
  ds_read_b64_tr_b16 v[62:63], v32 offset:19904
  s_waitcnt lgkmcnt(12)
  v_mfma_f32_32x32x16_bf16 v[144:159], v[72:75], a[24:27], v[144:159]
  ds_read_b64_tr_b16 v[64:65], v32 offset:16352
  ds_read_b64_tr_b16 v[66:67], v32 offset:19936
  v_mfma_f32_32x32x16_bf16 v[160:175], v[76:79], a[24:27], v[160:175]
  ds_read_b64_tr_b16 v[68:69], v32 offset:16384
  ds_read_b64_tr_b16 v[70:71], v32 offset:19968
  s_waitcnt lgkmcnt(10)
  v_mfma_f32_32x32x16_bf16 v[176:191], v[48:51], a[24:27], v[176:191]
  ds_read_b64_tr_b16 v[72:73], v32 offset:16416
  ds_read_b64_tr_b16 v[74:75], v32 offset:20000
  v_mfma_f32_32x32x16_bf16 v[80:95], v[52:55], a[28:31], v[80:95]
  ds_read_b64_tr_b16 v[76:77], v32 offset:16448
  ds_read_b64_tr_b16 v[78:79], v32 offset:20032
  s_waitcnt lgkmcnt(8)
  v_mfma_f32_32x32x16_bf16 v[96:111], v[56:59], a[28:31], v[96:111]
  s_barrier
  ds_read_b64_tr_b16 v[48:49], v33 offset:0
  ds_read_b64_tr_b16 v[50:51], v33 offset:3584
  v_mfma_f32_32x32x16_bf16 v[112:127], v[60:63], a[28:31], v[112:127]
  ds_read_b64_tr_b16 v[52:53], v33 offset:1792
  ds_read_b64_tr_b16 v[54:55], v33 offset:5376
  s_waitcnt lgkmcnt(8)
  v_mfma_f32_32x32x16_bf16 v[128:143], v[64:67], a[28:31], v[128:143]
  ds_read_b64_tr_b16 v[56:57], v33 offset:14464
  ds_read_b64_tr_b16 v[58:59], v33 offset:18048
  v_mfma_f32_32x32x16_bf16 v[144:159], v[68:71], a[28:31], v[144:159]
  ds_read_b64_tr_b16 v[60:61], v33 offset:16256
  ds_read_b64_tr_b16 v[62:63], v33 offset:19840
  s_waitcnt lgkmcnt(8)
  v_mfma_f32_32x32x16_bf16 v[160:175], v[72:75], a[28:31], v[160:175]
  ds_read_b64_tr_b16 v[64:65], v34 offset:0
  ds_read_b64_tr_b16 v[66:67], v34 offset:3584
  v_mfma_f32_32x32x16_bf16 v[176:191], v[76:79], a[28:31], v[176:191]
  ds_read_b64_tr_b16 v[68:69], v34 offset:1792
  ds_read_b64_tr_b16 v[70:71], v34 offset:5376
  s_waitcnt lgkmcnt(8)
  v_mfma_f32_32x32x16_bf16 v[80:95], v[48:51], a[32:35], v[80:95]
  ds_read_b64_tr_b16 v[72:73], v34 offset:14464
  ds_read_b64_tr_b16 v[74:75], v34 offset:18048
  v_mfma_f32_32x32x16_bf16 v[80:95], v[52:55], a[36:39], v[80:95]
  ds_read_b64_tr_b16 v[76:77], v34 offset:16256
  ds_read_b64_tr_b16 v[78:79], v34 offset:19840
  s_waitcnt lgkmcnt(8)
  v_mfma_f32_32x32x16_bf16 v[80:95], v[56:59], a[40:43], v[80:95]
  ds_read_b64_tr_b16 v[48:49], v33 offset:32
  ds_read_b64_tr_b16 v[50:51], v33 offset:3616
  v_mfma_f32_32x32x16_bf16 v[80:95], v[60:63], a[44:47], v[80:95]
  ds_read_b64_tr_b16 v[52:53], v33 offset:1824
  ds_read_b64_tr_b16 v[54:55], v33 offset:5408
  s_waitcnt lgkmcnt(8)
  v_mfma_f32_32x32x16_bf16 v[80:95], v[64:67], a[48:51], v[80:95]
  ds_read_b64_tr_b16 v[56:57], v33 offset:14496
  ds_read_b64_tr_b16 v[58:59], v33 offset:18080
  v_mfma_f32_32x32x16_bf16 v[80:95], v[68:71], a[52:55], v[80:95]
  ds_read_b64_tr_b16 v[60:61], v33 offset:16288
  ds_read_b64_tr_b16 v[62:63], v33 offset:19872
  s_waitcnt lgkmcnt(8)
  s_waitcnt vmcnt(1)
  v_mfma_f32_32x32x16_bf16 v[80:95], v[72:75], a[56:59], v[80:95]
  ds_read_b64_tr_b16 v[64:65], v34 offset:32
  ds_read_b64_tr_b16 v[66:67], v34 offset:3616
  s_waitcnt vmcnt(0)
  v_mfma_f32_32x32x16_bf16 v[80:95], v[76:79], a[60:63], v[80:95]
  ds_read_b64_tr_b16 v[68:69], v34 offset:1824
  ds_read_b64_tr_b16 v[70:71], v34 offset:5408
  s_waitcnt lgkmcnt(8)
  v_mfma_f32_32x32x16_bf16 v[96:111], v[48:51], a[32:35], v[96:111]
  ds_read_b64_tr_b16 v[72:73], v34 offset:14496
  ds_read_b64_tr_b16 v[74:75], v34 offset:18080
  v_mfma_f32_32x32x16_bf16 v[96:111], v[52:55], a[36:39], v[96:111]
  ds_read_b64_tr_b16 v[76:77], v34 offset:16288
  ds_read_b64_tr_b16 v[78:79], v34 offset:19872
  s_nop 2
  v_fmac_f32 v80, v42, v12
  v_fmac_f32 v81, v42, v13
  v_fmac_f32 v82, v42, v14
  v_fmac_f32 v83, v42, v15
  s_waitcnt lgkmcnt(8)
  v_mfma_f32_32x32x16_bf16 v[96:111], v[56:59], a[40:43], v[96:111]
  ds_read_b64_tr_b16 v[48:49], v33 offset:64
  ds_read_b64_tr_b16 v[50:51], v33 offset:3648
  v_fmac_f32 v84, v42, v16
  v_fmac_f32 v85, v42, v17
  v_fmac_f32 v86, v42, v18
  v_fmac_f32 v87, v42, v19
  v_mfma_f32_32x32x16_bf16 v[96:111], v[60:63], a[44:47], v[96:111]
  ds_read_b64_tr_b16 v[52:53], v33 offset:1856
  ds_read_b64_tr_b16 v[54:55], v33 offset:5440
  v_fmac_f32 v88, v42, v20
  v_fmac_f32 v89, v42, v21
  v_fmac_f32 v90, v42, v22
  v_fmac_f32 v91, v42, v23
  s_waitcnt lgkmcnt(8)
  v_mfma_f32_32x32x16_bf16 v[96:111], v[64:67], a[48:51], v[96:111]
  ds_read_b64_tr_b16 v[56:57], v33 offset:14528
  ds_read_b64_tr_b16 v[58:59], v33 offset:18112
  v_fmac_f32 v92, v42, v24
  v_fmac_f32 v93, v42, v25
  v_fmac_f32 v94, v42, v26
  v_fmac_f32 v95, v42, v27
  v_mfma_f32_32x32x16_bf16 v[96:111], v[68:71], a[52:55], v[96:111]
  ds_read_b64_tr_b16 v[60:61], v33 offset:16320
  ds_read_b64_tr_b16 v[62:63], v33 offset:19904
  ds_read_b128 v[12:15], v41 offset:128
  ds_read_b128 v[16:19], v41 offset:160
  ds_read_b128 v[20:23], v41 offset:192
  ds_read_b128 v[24:27], v41 offset:224
  s_waitcnt lgkmcnt(12)
  v_mfma_f32_32x32x16_bf16 v[96:111], v[72:75], a[56:59], v[96:111]
  ds_read_b64_tr_b16 v[64:65], v34 offset:64
  ds_read_b64_tr_b16 v[66:67], v34 offset:3648
  v_mul_f32 v80, v44, v80
  v_mul_f32 v81, v44, v81
  v_mul_f32 v82, v44, v82
  v_mul_f32 v83, v44, v83
  v_mfma_f32_32x32x16_bf16 v[96:111], v[76:79], a[60:63], v[96:111]
  ds_read_b64_tr_b16 v[68:69], v34 offset:1856
  ds_read_b64_tr_b16 v[70:71], v34 offset:5440
  v_mul_f32 v84, v44, v84
  v_mul_f32 v85, v44, v85
  v_mul_f32 v86, v44, v86
  v_mul_f32 v87, v44, v87
  s_waitcnt lgkmcnt(12)
  v_mfma_f32_32x32x16_bf16 v[112:127], v[48:51], a[32:35], v[112:127]
  ds_read_b64_tr_b16 v[72:73], v34 offset:14528
  ds_read_b64_tr_b16 v[74:75], v34 offset:18112
  v_mul_f32 v88, v80, v88
  v_exp_f32 v80, v80
  v_mul_f32 v89, v81, v89
  v_exp_f32 v81, v81
  v_mfma_f32_32x32x16_bf16 v[112:127], v[52:55], a[36:39], v[112:127]
  ds_read_b64_tr_b16 v[76:77], v34 offset:16320
  ds_read_b64_tr_b16 v[78:79], v34 offset:19904
  v_mul_f32 v90, v82, v90
  v_exp_f32 v82, v82
  v_mul_f32 v91, v83, v91
  v_exp_f32 v83, v83
  s_waitcnt lgkmcnt(12)
  v_mfma_f32_32x32x16_bf16 v[112:127], v[56:59], a[40:43], v[112:127]
  ds_read_b64_tr_b16 v[48:49], v33 offset:96
  ds_read_b64_tr_b16 v[50:51], v33 offset:3680
  v_mul_f32 v92, v84, v92
  v_exp_f32 v84, v84
  v_mul_f32 v93, v85, v93
  v_exp_f32 v85, v85
  v_mfma_f32_32x32x16_bf16 v[112:127], v[60:63], a[44:47], v[112:127]
  ds_read_b64_tr_b16 v[52:53], v33 offset:1888
  ds_read_b64_tr_b16 v[54:55], v33 offset:5472
  v_mul_f32 v94, v86, v94
  v_exp_f32 v86, v86
  v_mul_f32 v95, v87, v95
  v_exp_f32 v87, v87
  s_waitcnt lgkmcnt(8)
  v_mfma_f32_32x32x16_bf16 v[112:127], v[64:67], a[48:51], v[112:127]
  ds_read_b64_tr_b16 v[56:57], v33 offset:14560
  ds_read_b64_tr_b16 v[58:59], v33 offset:18144
  v_fma_f32 v80, v80, v46, v46
  v_fma_f32 v81, v81, v46, v46
  v_rcp_f32 v80, v80
  v_fma_f32 v82, v82, v46, v46
  v_mfma_f32_32x32x16_bf16 v[112:127], v[68:71], a[52:55], v[112:127]
  ds_read_b64_tr_b16 v[60:61], v33 offset:16352
  ds_read_b64_tr_b16 v[62:63], v33 offset:19936
  v_rcp_f32 v81, v81
  v_mul_f32 v88, v88, v80
  v_fma_f32 v83, v83, v46, v46
  v_rcp_f32 v82, v82
  s_waitcnt lgkmcnt(8)
  v_mfma_f32_32x32x16_bf16 v[112:127], v[72:75], a[56:59], v[112:127]
  s_barrier
  ds_read_b64_tr_b16 v[64:65], v34 offset:96
  ds_read_b64_tr_b16 v[66:67], v34 offset:3680
  v_mul_f32 v89, v89, v81
  v_fma_f32 v84, v84, v46, v46
  v_rcp_f32 v83, v83
  v_mul_f32 v90, v90, v82
  v_mfma_f32_32x32x16_bf16 v[112:127], v[76:79], a[60:63], v[112:127]
  ds_read_b64_tr_b16 v[68:69], v34 offset:1888
  ds_read_b64_tr_b16 v[70:71], v34 offset:5472
  v_fma_f32 v85, v85, v46, v46
  v_rcp_f32 v84, v84
  v_mul_f32 v91, v91, v83
  v_fma_f32 v86, v86, v46, v46
  s_waitcnt lgkmcnt(8)
  v_mfma_f32_32x32x16_bf16 v[128:143], v[48:51], a[32:35], v[128:143]
  ds_read_b64_tr_b16 v[72:73], v34 offset:14560
  ds_read_b64_tr_b16 v[74:75], v34 offset:18144
  v_rcp_f32 v85, v85
  v_mul_f32 v92, v92, v84
  v_fma_f32 v87, v87, v46, v46
  v_rcp_f32 v86, v86
  v_mfma_f32_32x32x16_bf16 v[128:143], v[52:55], a[36:39], v[128:143]
  ds_read_b64_tr_b16 v[76:77], v34 offset:16352
  ds_read_b64_tr_b16 v[78:79], v34 offset:19936
  v_mul_f32 v93, v93, v85
  v_rcp_f32 v87, v87
  v_mul_f32 v94, v94, v86
  v_cvt_pk_bf16_f32 v80, v88, v89
  s_waitcnt lgkmcnt(8)
  v_mfma_f32_32x32x16_bf16 v[128:143], v[56:59], a[40:43], v[128:143]
  ds_read_b64_tr_b16 v[48:49], v33 offset:128
  ds_read_b64_tr_b16 v[50:51], v33 offset:3712
  v_mul_f32 v95, v95, v87
  v_cvt_pk_bf16_f32 v81, v90, v91
  v_cvt_pk_bf16_f32 v82, v92, v93
  v_cvt_pk_bf16_f32 v83, v94, v95
  v_mfma_f32_32x32x16_bf16 v[128:143], v[60:63], a[44:47], v[128:143]
  ds_read_b64_tr_b16 v[52:53], v33 offset:1920
  ds_read_b64_tr_b16 v[54:55], v33 offset:5504
  buffer_store_dwordx4 v[80:83], v40, s[48:51], s90 offen offset:0 sc1
  s_waitcnt lgkmcnt(8)
  v_mfma_f32_32x32x16_bf16 v[128:143], v[64:67], a[48:51], v[128:143]
  ds_read_b64_tr_b16 v[56:57], v33 offset:14592
  ds_read_b64_tr_b16 v[58:59], v33 offset:18176
  v_fmac_f32 v96, v42, v12
  v_fmac_f32 v97, v42, v13
  v_fmac_f32 v98, v42, v14
  v_fmac_f32 v99, v42, v15
  v_mfma_f32_32x32x16_bf16 v[128:143], v[68:71], a[52:55], v[128:143]
  ds_read_b64_tr_b16 v[60:61], v33 offset:16384
  ds_read_b64_tr_b16 v[62:63], v33 offset:19968
  v_fmac_f32 v100, v42, v16
  v_fmac_f32 v101, v42, v17
  v_fmac_f32 v102, v42, v18
  v_fmac_f32 v103, v42, v19
  s_waitcnt lgkmcnt(8)
  v_mfma_f32_32x32x16_bf16 v[128:143], v[72:75], a[56:59], v[128:143]
  ds_read_b64_tr_b16 v[64:65], v34 offset:128
  ds_read_b64_tr_b16 v[66:67], v34 offset:3712
  v_fmac_f32 v104, v42, v20
  v_fmac_f32 v105, v42, v21
  v_fmac_f32 v106, v42, v22
  v_fmac_f32 v107, v42, v23
  v_mfma_f32_32x32x16_bf16 v[128:143], v[76:79], a[60:63], v[128:143]
  ds_read_b64_tr_b16 v[68:69], v34 offset:1920
  ds_read_b64_tr_b16 v[70:71], v34 offset:5504
  v_fmac_f32 v108, v42, v24
  v_fmac_f32 v109, v42, v25
  v_fmac_f32 v110, v42, v26
  v_fmac_f32 v111, v42, v27
  s_waitcnt lgkmcnt(8)
  v_mfma_f32_32x32x16_bf16 v[144:159], v[48:51], a[32:35], v[144:159]
  ds_read_b64_tr_b16 v[72:73], v34 offset:14592
  ds_read_b64_tr_b16 v[74:75], v34 offset:18176
  ds_read_b128 v[12:15], v41 offset:256
  ds_read_b128 v[16:19], v41 offset:288
  ds_read_b128 v[20:23], v41 offset:320
  ds_read_b128 v[24:27], v41 offset:352
  v_mfma_f32_32x32x16_bf16 v[144:159], v[52:55], a[36:39], v[144:159]
  ds_read_b64_tr_b16 v[76:77], v34 offset:16384
  ds_read_b64_tr_b16 v[78:79], v34 offset:19968
  v_mul_f32 v96, v44, v96
  v_mul_f32 v97, v44, v97
  v_mul_f32 v98, v44, v98
  v_mul_f32 v99, v44, v99
  s_waitcnt lgkmcnt(12)
  v_mfma_f32_32x32x16_bf16 v[144:159], v[56:59], a[40:43], v[144:159]
  ds_read_b64_tr_b16 v[48:49], v33 offset:160
  ds_read_b64_tr_b16 v[50:51], v33 offset:3744
  v_mul_f32 v100, v44, v100
  v_mul_f32 v101, v44, v101
  v_mul_f32 v102, v44, v102
  v_mul_f32 v103, v44, v103
  v_mfma_f32_32x32x16_bf16 v[144:159], v[60:63], a[44:47], v[144:159]
  ds_read_b64_tr_b16 v[52:53], v33 offset:1952
  ds_read_b64_tr_b16 v[54:55], v33 offset:5536
  v_mul_f32 v104, v96, v104
  v_exp_f32 v96, v96
  v_mul_f32 v105, v97, v105
  v_exp_f32 v97, v97
  s_waitcnt lgkmcnt(12)
  v_mfma_f32_32x32x16_bf16 v[144:159], v[64:67], a[48:51], v[144:159]
  ds_read_b64_tr_b16 v[56:57], v33 offset:14624
  ds_read_b64_tr_b16 v[58:59], v33 offset:18208
  v_mul_f32 v106, v98, v106
  v_exp_f32 v98, v98
  v_mul_f32 v107, v99, v107
  v_exp_f32 v99, v99
  v_mfma_f32_32x32x16_bf16 v[144:159], v[68:71], a[52:55], v[144:159]
  ds_read_b64_tr_b16 v[60:61], v33 offset:16416
  ds_read_b64_tr_b16 v[62:63], v33 offset:20000
  v_mul_f32 v108, v100, v108
  v_exp_f32 v100, v100
  v_mul_f32 v109, v101, v109
  v_exp_f32 v101, v101
  s_waitcnt lgkmcnt(8)
  v_mfma_f32_32x32x16_bf16 v[144:159], v[72:75], a[56:59], v[144:159]
  ds_read_b64_tr_b16 v[64:65], v34 offset:160
  ds_read_b64_tr_b16 v[66:67], v34 offset:3744
  v_mul_f32 v110, v102, v110
  v_exp_f32 v102, v102
  v_mul_f32 v111, v103, v111
  v_exp_f32 v103, v103
  v_mfma_f32_32x32x16_bf16 v[144:159], v[76:79], a[60:63], v[144:159]
  ds_read_b64_tr_b16 v[68:69], v34 offset:1952
  ds_read_b64_tr_b16 v[70:71], v34 offset:5536
  v_fma_f32 v96, v96, v46, v46
  v_fma_f32 v97, v97, v46, v46
  v_rcp_f32 v96, v96
  v_fma_f32 v98, v98, v46, v46
  s_waitcnt lgkmcnt(8)
  v_mfma_f32_32x32x16_bf16 v[160:175], v[48:51], a[32:35], v[160:175]
  ds_read_b64_tr_b16 v[72:73], v34 offset:14624
  ds_read_b64_tr_b16 v[74:75], v34 offset:18208
  v_rcp_f32 v97, v97
  v_mul_f32 v104, v104, v96
  v_fma_f32 v99, v99, v46, v46
  v_rcp_f32 v98, v98
  v_mfma_f32_32x32x16_bf16 v[160:175], v[52:55], a[36:39], v[160:175]
  ds_read_b64_tr_b16 v[76:77], v34 offset:16416
  ds_read_b64_tr_b16 v[78:79], v34 offset:20000
  v_mul_f32 v105, v105, v97
  v_fma_f32 v100, v100, v46, v46
  v_rcp_f32 v99, v99
  v_mul_f32 v106, v106, v98
  s_waitcnt lgkmcnt(8)
  v_mfma_f32_32x32x16_bf16 v[160:175], v[56:59], a[40:43], v[160:175]
  ds_read_b64_tr_b16 v[48:49], v33 offset:192
  ds_read_b64_tr_b16 v[50:51], v33 offset:3776
  v_fma_f32 v101, v101, v46, v46
  v_rcp_f32 v100, v100
  v_mul_f32 v107, v107, v99
  v_fma_f32 v102, v102, v46, v46
  v_mfma_f32_32x32x16_bf16 v[160:175], v[60:63], a[44:47], v[160:175]
  ds_read_b64_tr_b16 v[52:53], v33 offset:1984
  ds_read_b64_tr_b16 v[54:55], v33 offset:5568
  v_rcp_f32 v101, v101
  v_mul_f32 v108, v108, v100
  v_fma_f32 v103, v103, v46, v46
  v_rcp_f32 v102, v102
  s_waitcnt lgkmcnt(8)
  v_mfma_f32_32x32x16_bf16 v[160:175], v[64:67], a[48:51], v[160:175]
  ds_read_b64_tr_b16 v[56:57], v33 offset:14656
  ds_read_b64_tr_b16 v[58:59], v33 offset:18240
  v_mul_f32 v109, v109, v101
  v_rcp_f32 v103, v103
  v_mul_f32 v110, v110, v102
  v_cvt_pk_bf16_f32 v96, v104, v105
  v_mfma_f32_32x32x16_bf16 v[160:175], v[68:71], a[52:55], v[160:175]
  ds_read_b64_tr_b16 v[60:61], v33 offset:16448
  ds_read_b64_tr_b16 v[62:63], v33 offset:20032
  v_mul_f32 v111, v111, v103
  v_cvt_pk_bf16_f32 v97, v106, v107
  v_cvt_pk_bf16_f32 v98, v108, v109
  v_cvt_pk_bf16_f32 v99, v110, v111
  s_waitcnt lgkmcnt(8)
  v_mfma_f32_32x32x16_bf16 v[160:175], v[72:75], a[56:59], v[160:175]
  ds_read_b64_tr_b16 v[64:65], v34 offset:192
  ds_read_b64_tr_b16 v[66:67], v34 offset:3776
  buffer_store_dwordx4 v[96:99], v40, s[48:51], s90 offen offset:512 sc1
  v_mfma_f32_32x32x16_bf16 v[160:175], v[76:79], a[60:63], v[160:175]
  ds_read_b64_tr_b16 v[68:69], v34 offset:1984
  ds_read_b64_tr_b16 v[70:71], v34 offset:5568
  v_fmac_f32 v112, v42, v12
  v_fmac_f32 v113, v42, v13
  v_fmac_f32 v114, v42, v14
  v_fmac_f32 v115, v42, v15
  s_waitcnt lgkmcnt(8)
  v_mfma_f32_32x32x16_bf16 v[176:191], v[48:51], a[32:35], v[176:191]
  ds_read_b64_tr_b16 v[72:73], v34 offset:14656
  ds_read_b64_tr_b16 v[74:75], v34 offset:18240
  v_fmac_f32 v116, v42, v16
  v_fmac_f32 v117, v42, v17
  v_fmac_f32 v118, v42, v18
  v_fmac_f32 v119, v42, v19
  v_mfma_f32_32x32x16_bf16 v[176:191], v[52:55], a[36:39], v[176:191]
  ds_read_b64_tr_b16 v[76:77], v34 offset:16448
  ds_read_b64_tr_b16 v[78:79], v34 offset:20032
  v_fmac_f32 v120, v42, v20
  v_fmac_f32 v121, v42, v21
  v_fmac_f32 v122, v42, v22
  v_fmac_f32 v123, v42, v23
  s_waitcnt lgkmcnt(8)
  v_mfma_f32_32x32x16_bf16 v[176:191], v[56:59], a[40:43], v[176:191]
  v_fmac_f32 v124, v42, v24
  v_fmac_f32 v125, v42, v25
  v_fmac_f32 v126, v42, v26
  v_fmac_f32 v127, v42, v27
  v_mfma_f32_32x32x16_bf16 v[176:191], v[60:63], a[44:47], v[176:191]
  ds_read_b128 v[12:15], v41 offset:384
  ds_read_b128 v[16:19], v41 offset:416
  ds_read_b128 v[20:23], v41 offset:448
  ds_read_b128 v[24:27], v41 offset:480
  s_waitcnt lgkmcnt(8)
  v_mfma_f32_32x32x16_bf16 v[176:191], v[64:67], a[48:51], v[176:191]
  v_mul_f32 v112, v44, v112
  v_mul_f32 v113, v44, v113
  v_mul_f32 v114, v44, v114
  v_mul_f32 v115, v44, v115
  v_mfma_f32_32x32x16_bf16 v[176:191], v[68:71], a[52:55], v[176:191]
  v_mul_f32 v116, v44, v116
  v_mul_f32 v117, v44, v117
  v_mul_f32 v118, v44, v118
  v_mul_f32 v119, v44, v119
  s_waitcnt lgkmcnt(4)
  v_mfma_f32_32x32x16_bf16 v[176:191], v[72:75], a[56:59], v[176:191]
  v_mul_f32 v120, v112, v120
  v_exp_f32 v112, v112
  v_mul_f32 v121, v113, v121
  v_exp_f32 v113, v113
  v_mfma_f32_32x32x16_bf16 v[176:191], v[76:79], a[60:63], v[176:191]
  v_mul_f32 v122, v114, v122
  v_exp_f32 v114, v114
  v_mul_f32 v123, v115, v123
  v_exp_f32 v115, v115
  s_barrier
  v_mul_f32 v124, v116, v124
  v_exp_f32 v116, v116
  v_mul_f32 v125, v117, v125
  v_exp_f32 v117, v117
  v_mul_f32 v126, v118, v126
  v_exp_f32 v118, v118
  v_mul_f32 v127, v119, v127
  v_exp_f32 v119, v119
  v_fma_f32 v112, v112, v46, v46
  v_fma_f32 v113, v113, v46, v46
  v_rcp_f32 v112, v112
  v_fma_f32 v114, v114, v46, v46
  v_rcp_f32 v113, v113
  v_mul_f32 v120, v120, v112
  v_fma_f32 v115, v115, v46, v46
  v_rcp_f32 v114, v114
  v_mul_f32 v121, v121, v113
  v_fma_f32 v116, v116, v46, v46
  v_rcp_f32 v115, v115
  v_mul_f32 v122, v122, v114
  v_fma_f32 v117, v117, v46, v46
  v_rcp_f32 v116, v116
  v_mul_f32 v123, v123, v115
  v_fma_f32 v118, v118, v46, v46
  v_rcp_f32 v117, v117
  v_mul_f32 v124, v124, v116
  v_fma_f32 v119, v119, v46, v46
  v_rcp_f32 v118, v118
  v_mul_f32 v125, v125, v117
  v_rcp_f32 v119, v119
  v_mul_f32 v126, v126, v118
  v_cvt_pk_bf16_f32 v112, v120, v121
  v_mul_f32 v127, v127, v119
  v_cvt_pk_bf16_f32 v113, v122, v123
  v_cvt_pk_bf16_f32 v114, v124, v125
  v_cvt_pk_bf16_f32 v115, v126, v127
  buffer_store_dwordx4 v[112:115], v40, s[48:51], s90 offen offset:1024 sc1
  s_waitcnt lgkmcnt(3)
  v_pk_fma_f32 v[128:129], v[42:43], v[12:13], v[128:129] op_sel_hi:[0,1,1]
  v_pk_fma_f32 v[130:131], v[42:43], v[14:15], v[130:131] op_sel_hi:[0,1,1]
  s_waitcnt lgkmcnt(2)
  v_pk_fma_f32 v[132:133], v[42:43], v[16:17], v[132:133] op_sel_hi:[0,1,1]
  v_pk_fma_f32 v[134:135], v[42:43], v[18:19], v[134:135] op_sel_hi:[0,1,1]
  s_waitcnt lgkmcnt(1)
  v_pk_fma_f32 v[136:137], v[42:43], v[20:21], v[136:137] op_sel_hi:[0,1,1]
  v_pk_fma_f32 v[138:139], v[42:43], v[22:23], v[138:139] op_sel_hi:[0,1,1]
  s_waitcnt lgkmcnt(0)
  v_pk_fma_f32 v[140:141], v[42:43], v[24:25], v[140:141] op_sel_hi:[0,1,1]
  v_pk_fma_f32 v[142:143], v[42:43], v[26:27], v[142:143] op_sel_hi:[0,1,1]
  ds_read_b128 v[12:15], v41 offset:512
  ds_read_b128 v[16:19], v41 offset:544
  ds_read_b128 v[20:23], v41 offset:576
  ds_read_b128 v[24:27], v41 offset:608
  v_pk_mul_f32 v[128:129], v[44:45], v[128:129] op_sel_hi:[0,1]
  v_pk_mul_f32 v[130:131], v[44:45], v[130:131] op_sel_hi:[0,1]
  v_pk_mul_f32 v[132:133], v[44:45], v[132:133] op_sel_hi:[0,1]
  v_pk_mul_f32 v[134:135], v[44:45], v[134:135] op_sel_hi:[0,1]
  v_pk_mul_f32 v[136:137], v[128:129], v[136:137] op_sel_hi:[1,1]
  v_pk_mul_f32 v[138:139], v[130:131], v[138:139] op_sel_hi:[1,1]
  v_pk_mul_f32 v[140:141], v[132:133], v[140:141] op_sel_hi:[1,1]
  v_pk_mul_f32 v[142:143], v[134:135], v[142:143] op_sel_hi:[1,1]
  v_exp_f32 v128, v128
  v_exp_f32 v129, v129
  v_exp_f32 v130, v130
  v_exp_f32 v131, v131
  v_exp_f32 v132, v132
  v_exp_f32 v133, v133
  v_exp_f32 v134, v134
  v_exp_f32 v135, v135
  v_pk_fma_f32 v[128:129], v[128:129], v[46:47], v[46:47] op_sel_hi:[1,0,0]
  v_pk_fma_f32 v[130:131], v[130:131], v[46:47], v[46:47] op_sel_hi:[1,0,0]
  v_pk_fma_f32 v[132:133], v[132:133], v[46:47], v[46:47] op_sel_hi:[1,0,0]
  v_pk_fma_f32 v[134:135], v[134:135], v[46:47], v[46:47] op_sel_hi:[1,0,0]
  v_rcp_f32 v128, v128
  v_rcp_f32 v129, v129
  v_rcp_f32 v130, v130
  v_rcp_f32 v131, v131
  v_rcp_f32 v132, v132
  v_rcp_f32 v133, v133
  v_rcp_f32 v134, v134
  v_rcp_f32 v135, v135
  v_pk_mul_f32 v[136:137], v[136:137], v[128:129] op_sel_hi:[1,1]
  v_pk_mul_f32 v[138:139], v[138:139], v[130:131] op_sel_hi:[1,1]
  v_pk_mul_f32 v[140:141], v[140:141], v[132:133] op_sel_hi:[1,1]
  v_pk_mul_f32 v[142:143], v[142:143], v[134:135] op_sel_hi:[1,1]
  v_cvt_pk_bf16_f32 v128, v136, v137
  v_cvt_pk_bf16_f32 v129, v138, v139
  v_cvt_pk_bf16_f32 v130, v140, v141
  v_cvt_pk_bf16_f32 v131, v142, v143
  buffer_store_dwordx4 v[128:131], v40, s[48:51], s90 offen offset:1536 sc1
  s_waitcnt lgkmcnt(3)
  v_pk_fma_f32 v[144:145], v[42:43], v[12:13], v[144:145] op_sel_hi:[0,1,1]
  v_pk_fma_f32 v[146:147], v[42:43], v[14:15], v[146:147] op_sel_hi:[0,1,1]
  s_waitcnt lgkmcnt(2)
  v_pk_fma_f32 v[148:149], v[42:43], v[16:17], v[148:149] op_sel_hi:[0,1,1]
  v_pk_fma_f32 v[150:151], v[42:43], v[18:19], v[150:151] op_sel_hi:[0,1,1]
  s_waitcnt lgkmcnt(1)
  v_pk_fma_f32 v[152:153], v[42:43], v[20:21], v[152:153] op_sel_hi:[0,1,1]
  v_pk_fma_f32 v[154:155], v[42:43], v[22:23], v[154:155] op_sel_hi:[0,1,1]
  s_waitcnt lgkmcnt(0)
  v_pk_fma_f32 v[156:157], v[42:43], v[24:25], v[156:157] op_sel_hi:[0,1,1]
  v_pk_fma_f32 v[158:159], v[42:43], v[26:27], v[158:159] op_sel_hi:[0,1,1]
  ds_read_b128 v[12:15], v41 offset:640
  ds_read_b128 v[16:19], v41 offset:672
  ds_read_b128 v[20:23], v41 offset:704
  ds_read_b128 v[24:27], v41 offset:736
  v_pk_mul_f32 v[144:145], v[44:45], v[144:145] op_sel_hi:[0,1]
  v_pk_mul_f32 v[146:147], v[44:45], v[146:147] op_sel_hi:[0,1]
  v_pk_mul_f32 v[148:149], v[44:45], v[148:149] op_sel_hi:[0,1]
  v_pk_mul_f32 v[150:151], v[44:45], v[150:151] op_sel_hi:[0,1]
  v_pk_mul_f32 v[152:153], v[144:145], v[152:153] op_sel_hi:[1,1]
  v_pk_mul_f32 v[154:155], v[146:147], v[154:155] op_sel_hi:[1,1]
  v_pk_mul_f32 v[156:157], v[148:149], v[156:157] op_sel_hi:[1,1]
  v_pk_mul_f32 v[158:159], v[150:151], v[158:159] op_sel_hi:[1,1]
  v_exp_f32 v144, v144
  v_exp_f32 v145, v145
  v_exp_f32 v146, v146
  v_exp_f32 v147, v147
  v_exp_f32 v148, v148
  v_exp_f32 v149, v149
  v_exp_f32 v150, v150
  v_exp_f32 v151, v151
  v_pk_fma_f32 v[144:145], v[144:145], v[46:47], v[46:47] op_sel_hi:[1,0,0]
  v_pk_fma_f32 v[146:147], v[146:147], v[46:47], v[46:47] op_sel_hi:[1,0,0]
  v_pk_fma_f32 v[148:149], v[148:149], v[46:47], v[46:47] op_sel_hi:[1,0,0]
  v_pk_fma_f32 v[150:151], v[150:151], v[46:47], v[46:47] op_sel_hi:[1,0,0]
  v_rcp_f32 v144, v144
  v_rcp_f32 v145, v145
  v_rcp_f32 v146, v146
  v_rcp_f32 v147, v147
  v_rcp_f32 v148, v148
  v_rcp_f32 v149, v149
  v_rcp_f32 v150, v150
  v_rcp_f32 v151, v151
  v_pk_mul_f32 v[152:153], v[152:153], v[144:145] op_sel_hi:[1,1]
  v_pk_mul_f32 v[154:155], v[154:155], v[146:147] op_sel_hi:[1,1]
  v_pk_mul_f32 v[156:157], v[156:157], v[148:149] op_sel_hi:[1,1]
  v_pk_mul_f32 v[158:159], v[158:159], v[150:151] op_sel_hi:[1,1]
  v_cvt_pk_bf16_f32 v144, v152, v153
  v_cvt_pk_bf16_f32 v145, v154, v155
  v_cvt_pk_bf16_f32 v146, v156, v157
  v_cvt_pk_bf16_f32 v147, v158, v159
  buffer_store_dwordx4 v[144:147], v40, s[48:51], s90 offen offset:2048 sc1
  s_waitcnt lgkmcnt(3)
  v_pk_fma_f32 v[160:161], v[42:43], v[12:13], v[160:161] op_sel_hi:[0,1,1]
  v_pk_fma_f32 v[162:163], v[42:43], v[14:15], v[162:163] op_sel_hi:[0,1,1]
  s_waitcnt lgkmcnt(2)
  v_pk_fma_f32 v[164:165], v[42:43], v[16:17], v[164:165] op_sel_hi:[0,1,1]
  v_pk_fma_f32 v[166:167], v[42:43], v[18:19], v[166:167] op_sel_hi:[0,1,1]
  s_waitcnt lgkmcnt(1)
  v_pk_fma_f32 v[168:169], v[42:43], v[20:21], v[168:169] op_sel_hi:[0,1,1]
  v_pk_fma_f32 v[170:171], v[42:43], v[22:23], v[170:171] op_sel_hi:[0,1,1]
  s_waitcnt lgkmcnt(0)
  v_pk_fma_f32 v[172:173], v[42:43], v[24:25], v[172:173] op_sel_hi:[0,1,1]
  v_pk_fma_f32 v[174:175], v[42:43], v[26:27], v[174:175] op_sel_hi:[0,1,1]
  ds_read_b128 v[12:15], v41 offset:768
  ds_read_b128 v[16:19], v41 offset:800
  ds_read_b128 v[20:23], v41 offset:832
  ds_read_b128 v[24:27], v41 offset:864
  v_pk_mul_f32 v[160:161], v[44:45], v[160:161] op_sel_hi:[0,1]
  v_pk_mul_f32 v[162:163], v[44:45], v[162:163] op_sel_hi:[0,1]
  v_pk_mul_f32 v[164:165], v[44:45], v[164:165] op_sel_hi:[0,1]
  v_pk_mul_f32 v[166:167], v[44:45], v[166:167] op_sel_hi:[0,1]
  v_pk_mul_f32 v[168:169], v[160:161], v[168:169] op_sel_hi:[1,1]
  v_pk_mul_f32 v[170:171], v[162:163], v[170:171] op_sel_hi:[1,1]
  v_pk_mul_f32 v[172:173], v[164:165], v[172:173] op_sel_hi:[1,1]
  v_pk_mul_f32 v[174:175], v[166:167], v[174:175] op_sel_hi:[1,1]
  v_exp_f32 v160, v160
  v_exp_f32 v161, v161
  v_exp_f32 v162, v162
  v_exp_f32 v163, v163
  v_exp_f32 v164, v164
  v_exp_f32 v165, v165
  v_exp_f32 v166, v166
  v_exp_f32 v167, v167
  v_pk_fma_f32 v[160:161], v[160:161], v[46:47], v[46:47] op_sel_hi:[1,0,0]
  v_pk_fma_f32 v[162:163], v[162:163], v[46:47], v[46:47] op_sel_hi:[1,0,0]
  v_pk_fma_f32 v[164:165], v[164:165], v[46:47], v[46:47] op_sel_hi:[1,0,0]
  v_pk_fma_f32 v[166:167], v[166:167], v[46:47], v[46:47] op_sel_hi:[1,0,0]
  v_rcp_f32 v160, v160
  v_rcp_f32 v161, v161
  v_rcp_f32 v162, v162
  v_rcp_f32 v163, v163
  v_rcp_f32 v164, v164
  v_rcp_f32 v165, v165
  v_rcp_f32 v166, v166
  v_rcp_f32 v167, v167
  v_pk_mul_f32 v[168:169], v[168:169], v[160:161] op_sel_hi:[1,1]
  v_pk_mul_f32 v[170:171], v[170:171], v[162:163] op_sel_hi:[1,1]
  v_pk_mul_f32 v[172:173], v[172:173], v[164:165] op_sel_hi:[1,1]
  v_pk_mul_f32 v[174:175], v[174:175], v[166:167] op_sel_hi:[1,1]
  v_cvt_pk_bf16_f32 v160, v168, v169
  v_cvt_pk_bf16_f32 v161, v170, v171
  v_cvt_pk_bf16_f32 v162, v172, v173
  v_cvt_pk_bf16_f32 v163, v174, v175
  buffer_store_dwordx4 v[160:163], v40, s[48:51], s90 offen offset:2560 sc1
  s_waitcnt lgkmcnt(3)
  v_pk_fma_f32 v[176:177], v[42:43], v[12:13], v[176:177] op_sel_hi:[0,1,1]
  v_pk_fma_f32 v[178:179], v[42:43], v[14:15], v[178:179] op_sel_hi:[0,1,1]
  s_waitcnt lgkmcnt(2)
  v_pk_fma_f32 v[180:181], v[42:43], v[16:17], v[180:181] op_sel_hi:[0,1,1]
  v_pk_fma_f32 v[182:183], v[42:43], v[18:19], v[182:183] op_sel_hi:[0,1,1]
  s_waitcnt lgkmcnt(1)
  v_pk_fma_f32 v[184:185], v[42:43], v[20:21], v[184:185] op_sel_hi:[0,1,1]
  v_pk_fma_f32 v[186:187], v[42:43], v[22:23], v[186:187] op_sel_hi:[0,1,1]
  s_waitcnt lgkmcnt(0)
  v_pk_fma_f32 v[188:189], v[42:43], v[24:25], v[188:189] op_sel_hi:[0,1,1]
  v_pk_fma_f32 v[190:191], v[42:43], v[26:27], v[190:191] op_sel_hi:[0,1,1]
  v_pk_mul_f32 v[176:177], v[44:45], v[176:177] op_sel_hi:[0,1]
  v_pk_mul_f32 v[178:179], v[44:45], v[178:179] op_sel_hi:[0,1]
  v_pk_mul_f32 v[180:181], v[44:45], v[180:181] op_sel_hi:[0,1]
  v_pk_mul_f32 v[182:183], v[44:45], v[182:183] op_sel_hi:[0,1]
  v_pk_mul_f32 v[184:185], v[176:177], v[184:185] op_sel_hi:[1,1]
  v_pk_mul_f32 v[186:187], v[178:179], v[186:187] op_sel_hi:[1,1]
  v_pk_mul_f32 v[188:189], v[180:181], v[188:189] op_sel_hi:[1,1]
  v_pk_mul_f32 v[190:191], v[182:183], v[190:191] op_sel_hi:[1,1]
  v_exp_f32 v176, v176
  v_exp_f32 v177, v177
  v_exp_f32 v178, v178
  v_exp_f32 v179, v179
  v_exp_f32 v180, v180
  v_exp_f32 v181, v181
  v_exp_f32 v182, v182
  v_exp_f32 v183, v183
  v_pk_fma_f32 v[176:177], v[176:177], v[46:47], v[46:47] op_sel_hi:[1,0,0]
  v_pk_fma_f32 v[178:179], v[178:179], v[46:47], v[46:47] op_sel_hi:[1,0,0]
  v_pk_fma_f32 v[180:181], v[180:181], v[46:47], v[46:47] op_sel_hi:[1,0,0]
  v_pk_fma_f32 v[182:183], v[182:183], v[46:47], v[46:47] op_sel_hi:[1,0,0]
  v_rcp_f32 v176, v176
  v_rcp_f32 v177, v177
  v_rcp_f32 v178, v178
  v_rcp_f32 v179, v179
  v_rcp_f32 v180, v180
  v_rcp_f32 v181, v181
  v_rcp_f32 v182, v182
  v_rcp_f32 v183, v183
  v_pk_mul_f32 v[184:185], v[184:185], v[176:177] op_sel_hi:[1,1]
  v_pk_mul_f32 v[186:187], v[186:187], v[178:179] op_sel_hi:[1,1]
  v_pk_mul_f32 v[188:189], v[188:189], v[180:181] op_sel_hi:[1,1]
  v_pk_mul_f32 v[190:191], v[190:191], v[182:183] op_sel_hi:[1,1]
  v_cvt_pk_bf16_f32 v176, v184, v185
  v_cvt_pk_bf16_f32 v177, v186, v187
  v_cvt_pk_bf16_f32 v178, v188, v189
  v_cvt_pk_bf16_f32 v179, v190, v191
  buffer_store_dwordx4 v[176:179], v40, s[48:51], s90 offen offset:3072 sc1
  v_lshrrev_b32 v4, 1, v3
  v_lshlrev_b32 v4, 4, v4
  v_and_b32 v5, 1, v3
  v_lshl_add_u32 v4, v5, 2, v4
  v_lshrrev_b32 v5, 2, v2
  v_add_u32 v4, v4, v5
  v_lshrrev_b32 v5, 1, v4
  v_and_b32 v5, 3, v5
  v_lshlrev_b32 v5, 5, v5
  v_lshl_add_u32 v5, v4, 7, v5
  v_and_b32 v6, 3, v2
  v_lshl_add_u32 v5, v6, 3, v5
  v_xor_b32 v32, 0, v5
  v_xor_b32 v33, 32, v5
  v_xor_b32 v34, 64, v5
  v_xor_b32 v35, 96, v5
  s_mul_i32 s91, s58, 40960
  v_add_u32 v32, s91, v32
  v_add_u32 v33, s91, v33
  v_add_u32 v34, s91, v34
  v_add_u32 v35, s91, v35
  v_add_u32 v36, 0, v9
  v_add_u32 v37, 4096, v9
  v_add_u32 v38, 8192, v9
  v_add_u32 v39, 12288, v9
  s_sub_u32 s63, s62, s58
  s_mul_i32 s63, s63, 57344
  s_mul_i32 s64, s58, 14336
  s_add_u32 s63, s63, s64
  s_add_u32 s63, s63, 5242880
  s_add_u32 s64, s58, 0
  s_and_b32 s64, s64, 3
  s_mul_i32 s64, s64, 57344
  s_add_u32 s74, s63, s64
  s_add_u32 s64, s58, 1
  s_and_b32 s64, s64, 3
  s_mul_i32 s64, s64, 57344
  s_add_u32 s75, s63, s64
  s_add_u32 s64, s58, 2
  s_and_b32 s64, s64, 3
  s_mul_i32 s64, s64, 57344
  s_add_u32 s76, s63, s64
  s_add_u32 s64, s58, 3
  s_and_b32 s64, s64, 3
  s_mul_i32 s64, s64, 57344
  s_add_u32 s77, s63, s64
  v_add_u32 v27, s91, v9
  s_sub_u32 s64, s58, 1
  s_and_b32 s64, s64, 3
  s_mul_i32 s64, s64, 40960
  v_add_u32 v24, s64, v9
  s_sub_u32 s64, s58, 2
  s_and_b32 s64, s64, 3
  s_mul_i32 s64, s64, 40960
  v_add_u32 v25, s64, v9
  s_sub_u32 s64, s58, 3
  s_and_b32 s64, s64, 3
  s_mul_i32 s64, s64, 40960
  v_add_u32 v26, s64, v9
  v_and_b32 v4, 7, v2
  v_lshrrev_b32 v5, 1, v3
  v_xor_b32 v4, v4, v5
  v_lshlrev_b32 v4, 4, v4
  v_lshl_add_u32 v4, v2, 7, v4
  v_and_b32 v5, 1, v3
  v_lshl_add_u32 v4, v5, 3, v4
  s_add_u32 s63, s91, 16384
  v_xor_b32 v20, 0, v4
  v_add_u32 v20, s63, v20
  v_xor_b32 v21, 32, v4
  v_add_u32 v21, s63, v21
  v_xor_b32 v22, 64, v4
  v_add_u32 v22, s63, v22
  v_xor_b32 v23, 96, v4
  v_add_u32 v23, s63, v23
  v_lshrrev_b32 v4, 3, v1
  v_and_b32 v5, 7, v1
  v_xor_b32 v6, v5, v4
  v_lshlrev_b32 v6, 4, v6
  v_lshl_add_u32 v6, v4, 7, v6
  v_add_u32 v10, s63, v6
  v_lshlrev_b32 v4, 11, v4
  v_lshl_add_u32 v11, v5, 4, v4
  s_lshr_b32 s63, s62, 1
  s_lshl_b32 s63, s63, 15
  s_and_b32 s64, s62, 1
  s_lshl_b32 s64, s64, 10
  s_add_u32 s63, s63, s64
  s_lshl_b32 s64, s60, 7
  s_add_u32 s94, s63, s64
  s_add_u32 s95, s94, 16384
  buffer_load_dwordx4 v[12:15], v9, s[48:51], s68 offen offset:0 sc1
  buffer_load_dwordx4 v[16:19], v9, s[48:51], s68 offen offset:1024 sc1
  s_and_b32 s63, s56, 7
  s_lshl_b32 s63, s63, 12
  s_lshr_b32 s65, s56, 3
  s_lshl_b32 s65, s65, 9
  s_add_u32 s63, s63, s65
  s_add_u32 s63, s63, 524296
  v_and_b32 v7, 3, v2
  v_lshl_add_u32 v7, v7, 10, s63
  v_lshrrev_b32 v8, 2, v2
  v_lshl_add_u32 v8, v8, 7, v7
  s_waitcnt vmcnt(0) lgkmcnt(0)
  s_barrier
  ds_read_b64_tr_b16 v[44:45], v32 offset:0
  ds_read_b64_tr_b16 v[46:47], v32 offset:1024
  ds_read_b64_tr_b16 v[48:49], v33 offset:0
  ds_read_b64_tr_b16 v[50:51], v33 offset:1024
  ds_read_b64_tr_b16 v[52:53], v34 offset:0
  ds_read_b64_tr_b16 v[54:55], v34 offset:1024
  ds_read_b64_tr_b16 v[56:57], v35 offset:0
  ds_read_b64_tr_b16 v[58:59], v35 offset:1024
  ds_read_b64_tr_b16 v[60:61], v32 offset:4096
  ds_read_b64_tr_b16 v[62:63], v32 offset:5120
  ds_read_b64_tr_b16 v[64:65], v33 offset:4096
  ds_read_b64_tr_b16 v[66:67], v33 offset:5120
  ds_read_b64_tr_b16 v[68:69], v34 offset:4096
  ds_read_b64_tr_b16 v[70:71], v34 offset:5120
  ds_read_b64_tr_b16 v[72:73], v35 offset:4096
  ds_read_b64_tr_b16 v[74:75], v35 offset:5120
  ds_read_b64_tr_b16 v[76:77], v32 offset:8192
  ds_read_b64_tr_b16 v[78:79], v32 offset:9216
  ds_read_b64_tr_b16 v[80:81], v33 offset:8192
  ds_read_b64_tr_b16 v[82:83], v33 offset:9216
  ds_read_b64_tr_b16 v[84:85], v34 offset:8192
  ds_read_b64_tr_b16 v[86:87], v34 offset:9216
  ds_read_b64_tr_b16 v[88:89], v35 offset:8192
  ds_read_b64_tr_b16 v[90:91], v35 offset:9216
  ds_read_b64_tr_b16 v[92:93], v32 offset:12288
  ds_read_b64_tr_b16 v[94:95], v32 offset:13312
  ds_read_b64_tr_b16 v[96:97], v33 offset:12288
  ds_read_b64_tr_b16 v[98:99], v33 offset:13312
  ds_read_b64_tr_b16 v[100:101], v34 offset:12288
  ds_read_b64_tr_b16 v[102:103], v34 offset:13312
  ds_read_b64_tr_b16 v[104:105], v35 offset:12288
  ds_read_b64_tr_b16 v[106:107], v35 offset:13312
  s_waitcnt lgkmcnt(0)
  s_barrier
  s_cmp_lg_u32 s58, 0
  s_cbranch_scc1 L_f3_join
  s_mov_b64 exec, 0xffff
  s_mov_b32 s66, 0x10000
L_f3_p:
  buffer_load_dword v5, v8, s[48:51], 0 offen sc1
  s_waitcnt vmcnt(0)
  v_cmp_ne_u32 vcc, s59, v5
  s_nop 1
  s_cbranch_vccz L_f3_join
  s_sub_u32 s66, s66, 1
  s_cbranch_scc0 L_f3_p
L_f3_join:
  s_mov_b64 exec, -1
  s_barrier
  buffer_load_dwordx4 v[112:115], v36, s[48:51], s75 offen offset:0 sc1
  buffer_load_dwordx4 v[116:119], v36, s[48:51], s76 offen offset:0 sc1
  buffer_load_dwordx4 v[120:123], v36, s[48:51], s77 offen offset:0 sc1
  buffer_load_dwordx4 v[108:111], v36, s[48:51], s74 offen offset:0 sc1
  buffer_load_dwordx4 v[128:131], v36, s[48:51], s75 offen offset:1024 sc1
  buffer_load_dwordx4 v[132:135], v36, s[48:51], s76 offen offset:1024 sc1
  buffer_load_dwordx4 v[136:139], v36, s[48:51], s77 offen offset:1024 sc1
  buffer_load_dwordx4 v[124:127], v36, s[48:51], s74 offen offset:1024 sc1
  buffer_load_dwordx4 v[144:147], v36, s[48:51], s75 offen offset:2048 sc1
  buffer_load_dwordx4 v[148:151], v36, s[48:51], s76 offen offset:2048 sc1
  buffer_load_dwordx4 v[152:155], v36, s[48:51], s77 offen offset:2048 sc1
  buffer_load_dwordx4 v[140:143], v36, s[48:51], s74 offen offset:2048 sc1
  buffer_load_dwordx4 v[160:163], v36, s[48:51], s75 offen offset:3072 sc1
  buffer_load_dwordx4 v[164:167], v36, s[48:51], s76 offen offset:3072 sc1
  buffer_load_dwordx4 v[168:171], v36, s[48:51], s77 offen offset:3072 sc1
  buffer_load_dwordx4 v[156:159], v36, s[48:51], s74 offen offset:3072 sc1
  buffer_load_dwordx4 v[176:179], v37, s[48:51], s75 offen offset:0 sc1
  buffer_load_dwordx4 v[180:183], v37, s[48:51], s76 offen offset:0 sc1
  buffer_load_dwordx4 v[184:187], v37, s[48:51], s77 offen offset:0 sc1
  buffer_load_dwordx4 v[172:175], v37, s[48:51], s74 offen offset:0 sc1
  s_waitcnt vmcnt(19)
  v_mfma_f32_16x16x32_bf16 a[16:19], v[44:47], v[112:115], 0
  v_mfma_f32_16x16x32_bf16 a[20:23], v[48:51], v[112:115], 0
  v_mfma_f32_16x16x32_bf16 a[24:27], v[52:55], v[112:115], 0
  v_mfma_f32_16x16x32_bf16 a[28:31], v[56:59], v[112:115], 0
  s_waitcnt vmcnt(18)
  v_mfma_f32_16x16x32_bf16 a[32:35], v[44:47], v[116:119], 0
  v_mfma_f32_16x16x32_bf16 a[36:39], v[48:51], v[116:119], 0
  buffer_load_dwordx4 v[112:115], v37, s[48:51], s75 offen offset:1024 sc1
  v_mfma_f32_16x16x32_bf16 a[40:43], v[52:55], v[116:119], 0
  v_mfma_f32_16x16x32_bf16 a[44:47], v[56:59], v[116:119], 0
  s_waitcnt vmcnt(18)
  v_mfma_f32_16x16x32_bf16 a[48:51], v[44:47], v[120:123], 0
  v_mfma_f32_16x16x32_bf16 a[52:55], v[48:51], v[120:123], 0
  buffer_load_dwordx4 v[116:119], v37, s[48:51], s76 offen offset:1024 sc1
  v_mfma_f32_16x16x32_bf16 a[56:59], v[52:55], v[120:123], 0
  v_mfma_f32_16x16x32_bf16 a[60:63], v[56:59], v[120:123], 0
  s_waitcnt vmcnt(18)
  v_mfma_f32_16x16x32_bf16 a[0:3], v[44:47], v[108:111], 0
  v_mfma_f32_16x16x32_bf16 a[4:7], v[48:51], v[108:111], 0
  buffer_load_dwordx4 v[120:123], v37, s[48:51], s77 offen offset:1024 sc1
  v_mfma_f32_16x16x32_bf16 a[8:11], v[52:55], v[108:111], 0
  v_mfma_f32_16x16x32_bf16 a[12:15], v[56:59], v[108:111], 0
  buffer_load_dwordx4 v[108:111], v37, s[48:51], s74 offen offset:1024 sc1
  s_waitcnt vmcnt(19)
  v_mfma_f32_16x16x32_bf16 a[16:19], v[60:63], v[128:131], a[16:19]
  v_mfma_f32_16x16x32_bf16 a[20:23], v[64:67], v[128:131], a[20:23]
  v_mfma_f32_16x16x32_bf16 a[24:27], v[68:71], v[128:131], a[24:27]
  v_mfma_f32_16x16x32_bf16 a[28:31], v[72:75], v[128:131], a[28:31]
  s_waitcnt vmcnt(18)
  v_mfma_f32_16x16x32_bf16 a[32:35], v[60:63], v[132:135], a[32:35]
  ds_read_b64_tr_b16 v[44:45], v32 offset:16384
  v_mfma_f32_16x16x32_bf16 a[36:39], v[64:67], v[132:135], a[36:39]
  ds_read_b64_tr_b16 v[46:47], v32 offset:17408
  buffer_load_dwordx4 v[128:131], v37, s[48:51], s75 offen offset:2048 sc1
  v_mfma_f32_16x16x32_bf16 a[40:43], v[68:71], v[132:135], a[40:43]
  ds_read_b64_tr_b16 v[48:49], v33 offset:16384
  v_mfma_f32_16x16x32_bf16 a[44:47], v[72:75], v[132:135], a[44:47]
  ds_read_b64_tr_b16 v[50:51], v33 offset:17408
  s_waitcnt vmcnt(18)
  v_mfma_f32_16x16x32_bf16 a[48:51], v[60:63], v[136:139], a[48:51]
  ds_read_b64_tr_b16 v[52:53], v34 offset:16384
  v_mfma_f32_16x16x32_bf16 a[52:55], v[64:67], v[136:139], a[52:55]
  ds_read_b64_tr_b16 v[54:55], v34 offset:17408
  buffer_load_dwordx4 v[132:135], v37, s[48:51], s76 offen offset:2048 sc1
  v_mfma_f32_16x16x32_bf16 a[56:59], v[68:71], v[136:139], a[56:59]
  ds_read_b64_tr_b16 v[56:57], v35 offset:16384
  v_mfma_f32_16x16x32_bf16 a[60:63], v[72:75], v[136:139], a[60:63]
  ds_read_b64_tr_b16 v[58:59], v35 offset:17408
  s_waitcnt vmcnt(18)
  v_mfma_f32_16x16x32_bf16 a[0:3], v[60:63], v[124:127], a[0:3]
  v_mfma_f32_16x16x32_bf16 a[4:7], v[64:67], v[124:127], a[4:7]
  buffer_load_dwordx4 v[136:139], v37, s[48:51], s77 offen offset:2048 sc1
  v_mfma_f32_16x16x32_bf16 a[8:11], v[68:71], v[124:127], a[8:11]
  v_mfma_f32_16x16x32_bf16 a[12:15], v[72:75], v[124:127], a[12:15]
  buffer_load_dwordx4 v[124:127], v37, s[48:51], s74 offen offset:2048 sc1
  s_waitcnt vmcnt(19)
  v_mfma_f32_16x16x32_bf16 a[16:19], v[76:79], v[144:147], a[16:19]
  v_mfma_f32_16x16x32_bf16 a[20:23], v[80:83], v[144:147], a[20:23]
  v_mfma_f32_16x16x32_bf16 a[24:27], v[84:87], v[144:147], a[24:27]
  v_mfma_f32_16x16x32_bf16 a[28:31], v[88:91], v[144:147], a[28:31]
  s_waitcnt vmcnt(18)
  v_mfma_f32_16x16x32_bf16 a[32:35], v[76:79], v[148:151], a[32:35]
  ds_read_b64_tr_b16 v[60:61], v32 offset:20480
  v_mfma_f32_16x16x32_bf16 a[36:39], v[80:83], v[148:151], a[36:39]
  ds_read_b64_tr_b16 v[62:63], v32 offset:21504
  buffer_load_dwordx4 v[144:147], v37, s[48:51], s75 offen offset:3072 sc1
  v_mfma_f32_16x16x32_bf16 a[40:43], v[84:87], v[148:151], a[40:43]
  ds_read_b64_tr_b16 v[64:65], v33 offset:20480
  v_mfma_f32_16x16x32_bf16 a[44:47], v[88:91], v[148:151], a[44:47]
  ds_read_b64_tr_b16 v[66:67], v33 offset:21504
  s_waitcnt vmcnt(18)
  v_mfma_f32_16x16x32_bf16 a[48:51], v[76:79], v[152:155], a[48:51]
  ds_read_b64_tr_b16 v[68:69], v34 offset:20480
  v_mfma_f32_16x16x32_bf16 a[52:55], v[80:83], v[152:155], a[52:55]
  ds_read_b64_tr_b16 v[70:71], v34 offset:21504
  buffer_load_dwordx4 v[148:151], v37, s[48:51], s76 offen offset:3072 sc1
  v_mfma_f32_16x16x32_bf16 a[56:59], v[84:87], v[152:155], a[56:59]
  ds_read_b64_tr_b16 v[72:73], v35 offset:20480
  v_mfma_f32_16x16x32_bf16 a[60:63], v[88:91], v[152:155], a[60:63]
  ds_read_b64_tr_b16 v[74:75], v35 offset:21504
  s_waitcnt vmcnt(18)
  v_mfma_f32_16x16x32_bf16 a[0:3], v[76:79], v[140:143], a[0:3]
  v_mfma_f32_16x16x32_bf16 a[4:7], v[80:83], v[140:143], a[4:7]
  buffer_load_dwordx4 v[152:155], v37, s[48:51], s77 offen offset:3072 sc1
  v_mfma_f32_16x16x32_bf16 a[8:11], v[84:87], v[140:143], a[8:11]
  v_mfma_f32_16x16x32_bf16 a[12:15], v[88:91], v[140:143], a[12:15]
  buffer_load_dwordx4 v[140:143], v37, s[48:51], s74 offen offset:3072 sc1
  s_waitcnt vmcnt(19)
  v_mfma_f32_16x16x32_bf16 a[16:19], v[92:95], v[160:163], a[16:19]
  v_mfma_f32_16x16x32_bf16 a[20:23], v[96:99], v[160:163], a[20:23]
  v_mfma_f32_16x16x32_bf16 a[24:27], v[100:103], v[160:163], a[24:27]
  v_mfma_f32_16x16x32_bf16 a[28:31], v[104:107], v[160:163], a[28:31]
  s_waitcnt vmcnt(18)
  v_mfma_f32_16x16x32_bf16 a[32:35], v[92:95], v[164:167], a[32:35]
  ds_read_b64_tr_b16 v[76:77], v32 offset:24576
  v_mfma_f32_16x16x32_bf16 a[36:39], v[96:99], v[164:167], a[36:39]
  ds_read_b64_tr_b16 v[78:79], v32 offset:25600
  buffer_load_dwordx4 v[160:163], v38, s[48:51], s75 offen offset:0 sc1
  v_mfma_f32_16x16x32_bf16 a[40:43], v[100:103], v[164:167], a[40:43]
  ds_read_b64_tr_b16 v[80:81], v33 offset:24576
  v_mfma_f32_16x16x32_bf16 a[44:47], v[104:107], v[164:167], a[44:47]
  ds_read_b64_tr_b16 v[82:83], v33 offset:25600
  s_waitcnt vmcnt(18)
  v_mfma_f32_16x16x32_bf16 a[48:51], v[92:95], v[168:171], a[48:51]
  ds_read_b64_tr_b16 v[84:85], v34 offset:24576
  v_mfma_f32_16x16x32_bf16 a[52:55], v[96:99], v[168:171], a[52:55]
  ds_read_b64_tr_b16 v[86:87], v34 offset:25600
  buffer_load_dwordx4 v[164:167], v38, s[48:51], s76 offen offset:0 sc1
  v_mfma_f32_16x16x32_bf16 a[56:59], v[100:103], v[168:171], a[56:59]
  ds_read_b64_tr_b16 v[88:89], v35 offset:24576
  v_mfma_f32_16x16x32_bf16 a[60:63], v[104:107], v[168:171], a[60:63]
  ds_read_b64_tr_b16 v[90:91], v35 offset:25600
  s_waitcnt vmcnt(18)
  v_mfma_f32_16x16x32_bf16 a[0:3], v[92:95], v[156:159], a[0:3]
  v_mfma_f32_16x16x32_bf16 a[4:7], v[96:99], v[156:159], a[4:7]
  buffer_load_dwordx4 v[168:171], v38, s[48:51], s77 offen offset:0 sc1
  v_mfma_f32_16x16x32_bf16 a[8:11], v[100:103], v[156:159], a[8:11]
  v_mfma_f32_16x16x32_bf16 a[12:15], v[104:107], v[156:159], a[12:15]
  buffer_load_dwordx4 v[156:159], v38, s[48:51], s74 offen offset:0 sc1
  s_waitcnt lgkmcnt(15)
  s_waitcnt vmcnt(19)
  v_mfma_f32_16x16x32_bf16 a[16:19], v[44:47], v[176:179], a[16:19]
  v_mfma_f32_16x16x32_bf16 a[20:23], v[48:51], v[176:179], a[20:23]
  v_mfma_f32_16x16x32_bf16 a[24:27], v[52:55], v[176:179], a[24:27]
  v_mfma_f32_16x16x32_bf16 a[28:31], v[56:59], v[176:179], a[28:31]
  s_waitcnt vmcnt(18)
  v_mfma_f32_16x16x32_bf16 a[32:35], v[44:47], v[180:183], a[32:35]
  ds_read_b64_tr_b16 v[92:93], v32 offset:28672
  v_mfma_f32_16x16x32_bf16 a[36:39], v[48:51], v[180:183], a[36:39]
  ds_read_b64_tr_b16 v[94:95], v32 offset:29696
  buffer_load_dwordx4 v[176:179], v38, s[48:51], s75 offen offset:1024 sc1
  v_mfma_f32_16x16x32_bf16 a[40:43], v[52:55], v[180:183], a[40:43]
  ds_read_b64_tr_b16 v[96:97], v33 offset:28672
  v_mfma_f32_16x16x32_bf16 a[44:47], v[56:59], v[180:183], a[44:47]
  ds_read_b64_tr_b16 v[98:99], v33 offset:29696
  s_waitcnt vmcnt(18)
  v_mfma_f32_16x16x32_bf16 a[48:51], v[44:47], v[184:187], a[48:51]
  ds_read_b64_tr_b16 v[100:101], v34 offset:28672
  v_mfma_f32_16x16x32_bf16 a[52:55], v[48:51], v[184:187], a[52:55]
  ds_read_b64_tr_b16 v[102:103], v34 offset:29696
  buffer_load_dwordx4 v[180:183], v38, s[48:51], s76 offen offset:1024 sc1
  v_mfma_f32_16x16x32_bf16 a[56:59], v[52:55], v[184:187], a[56:59]
  ds_read_b64_tr_b16 v[104:105], v35 offset:28672
  v_mfma_f32_16x16x32_bf16 a[60:63], v[56:59], v[184:187], a[60:63]
  ds_read_b64_tr_b16 v[106:107], v35 offset:29696
  s_waitcnt vmcnt(18)
  v_mfma_f32_16x16x32_bf16 a[0:3], v[44:47], v[172:175], a[0:3]
  v_mfma_f32_16x16x32_bf16 a[4:7], v[48:51], v[172:175], a[4:7]
  buffer_load_dwordx4 v[184:187], v38, s[48:51], s77 offen offset:1024 sc1
  v_mfma_f32_16x16x32_bf16 a[8:11], v[52:55], v[172:175], a[8:11]
  v_mfma_f32_16x16x32_bf16 a[12:15], v[56:59], v[172:175], a[12:15]
  buffer_load_dwordx4 v[172:175], v38, s[48:51], s74 offen offset:1024 sc1
  s_waitcnt lgkmcnt(15)
  s_waitcnt vmcnt(19)
  v_mfma_f32_16x16x32_bf16 a[16:19], v[60:63], v[112:115], a[16:19]
  v_mfma_f32_16x16x32_bf16 a[20:23], v[64:67], v[112:115], a[20:23]
  v_mfma_f32_16x16x32_bf16 a[24:27], v[68:71], v[112:115], a[24:27]
  v_mfma_f32_16x16x32_bf16 a[28:31], v[72:75], v[112:115], a[28:31]
  s_waitcnt vmcnt(18)
  v_mfma_f32_16x16x32_bf16 a[32:35], v[60:63], v[116:119], a[32:35]
  ds_read_b64_tr_b16 v[44:45], v32 offset:32768
  v_mfma_f32_16x16x32_bf16 a[36:39], v[64:67], v[116:119], a[36:39]
  ds_read_b64_tr_b16 v[46:47], v32 offset:33792
  buffer_load_dwordx4 v[112:115], v38, s[48:51], s75 offen offset:2048 sc1
  v_mfma_f32_16x16x32_bf16 a[40:43], v[68:71], v[116:119], a[40:43]
  ds_read_b64_tr_b16 v[48:49], v33 offset:32768
  v_mfma_f32_16x16x32_bf16 a[44:47], v[72:75], v[116:119], a[44:47]
  ds_read_b64_tr_b16 v[50:51], v33 offset:33792
  s_waitcnt vmcnt(18)
  v_mfma_f32_16x16x32_bf16 a[48:51], v[60:63], v[120:123], a[48:51]
  ds_read_b64_tr_b16 v[52:53], v34 offset:32768
  v_mfma_f32_16x16x32_bf16 a[52:55], v[64:67], v[120:123], a[52:55]
  ds_read_b64_tr_b16 v[54:55], v34 offset:33792
  buffer_load_dwordx4 v[116:119], v38, s[48:51], s76 offen offset:2048 sc1
  v_mfma_f32_16x16x32_bf16 a[56:59], v[68:71], v[120:123], a[56:59]
  ds_read_b64_tr_b16 v[56:57], v35 offset:32768
  v_mfma_f32_16x16x32_bf16 a[60:63], v[72:75], v[120:123], a[60:63]
  ds_read_b64_tr_b16 v[58:59], v35 offset:33792
  s_waitcnt vmcnt(18)
  v_mfma_f32_16x16x32_bf16 a[0:3], v[60:63], v[108:111], a[0:3]
  v_mfma_f32_16x16x32_bf16 a[4:7], v[64:67], v[108:111], a[4:7]
  buffer_load_dwordx4 v[120:123], v38, s[48:51], s77 offen offset:2048 sc1
  v_mfma_f32_16x16x32_bf16 a[8:11], v[68:71], v[108:111], a[8:11]
  v_mfma_f32_16x16x32_bf16 a[12:15], v[72:75], v[108:111], a[12:15]
  buffer_load_dwordx4 v[108:111], v38, s[48:51], s74 offen offset:2048 sc1
  s_waitcnt lgkmcnt(15)
  s_waitcnt vmcnt(19)
  v_mfma_f32_16x16x32_bf16 a[16:19], v[76:79], v[128:131], a[16:19]
  v_mfma_f32_16x16x32_bf16 a[20:23], v[80:83], v[128:131], a[20:23]
  v_mfma_f32_16x16x32_bf16 a[24:27], v[84:87], v[128:131], a[24:27]
  v_mfma_f32_16x16x32_bf16 a[28:31], v[88:91], v[128:131], a[28:31]
  s_barrier
  s_waitcnt vmcnt(18)
  v_mfma_f32_16x16x32_bf16 a[32:35], v[76:79], v[132:135], a[32:35]
  ds_read_b64_tr_b16 v[60:61], v32 offset:36864
  v_mfma_f32_16x16x32_bf16 a[36:39], v[80:83], v[132:135], a[36:39]
  ds_read_b64_tr_b16 v[62:63], v32 offset:37888
  buffer_load_dwordx4 v[128:131], v38, s[48:51], s75 offen offset:3072 sc1
  v_mfma_f32_16x16x32_bf16 a[40:43], v[84:87], v[132:135], a[40:43]
  ds_read_b64_tr_b16 v[64:65], v33 offset:36864
  v_mfma_f32_16x16x32_bf16 a[44:47], v[88:91], v[132:135], a[44:47]
  ds_read_b64_tr_b16 v[66:67], v33 offset:37888
  s_waitcnt vmcnt(18)
  v_mfma_f32_16x16x32_bf16 a[48:51], v[76:79], v[136:139], a[48:51]
  ds_read_b64_tr_b16 v[68:69], v34 offset:36864
  v_mfma_f32_16x16x32_bf16 a[52:55], v[80:83], v[136:139], a[52:55]
  ds_read_b64_tr_b16 v[70:71], v34 offset:37888
  buffer_load_dwordx4 v[132:135], v38, s[48:51], s76 offen offset:3072 sc1
  v_mfma_f32_16x16x32_bf16 a[56:59], v[84:87], v[136:139], a[56:59]
  ds_read_b64_tr_b16 v[72:73], v35 offset:36864
  v_mfma_f32_16x16x32_bf16 a[60:63], v[88:91], v[136:139], a[60:63]
  ds_read_b64_tr_b16 v[74:75], v35 offset:37888
  s_waitcnt vmcnt(18)
  v_mfma_f32_16x16x32_bf16 a[0:3], v[76:79], v[124:127], a[0:3]
  v_mfma_f32_16x16x32_bf16 a[4:7], v[80:83], v[124:127], a[4:7]
  buffer_load_dwordx4 v[136:139], v38, s[48:51], s77 offen offset:3072 sc1
  v_mfma_f32_16x16x32_bf16 a[8:11], v[84:87], v[124:127], a[8:11]
  v_mfma_f32_16x16x32_bf16 a[12:15], v[88:91], v[124:127], a[12:15]
  buffer_load_dwordx4 v[124:127], v38, s[48:51], s74 offen offset:3072 sc1
  s_waitcnt lgkmcnt(15)
  s_waitcnt vmcnt(19)
  v_mfma_f32_16x16x32_bf16 a[16:19], v[92:95], v[144:147], a[16:19]
  v_mfma_f32_16x16x32_bf16 a[20:23], v[96:99], v[144:147], a[20:23]
  v_mfma_f32_16x16x32_bf16 a[24:27], v[100:103], v[144:147], a[24:27]
  v_mfma_f32_16x16x32_bf16 a[28:31], v[104:107], v[144:147], a[28:31]
  s_waitcnt vmcnt(18)
  v_mfma_f32_16x16x32_bf16 a[32:35], v[92:95], v[148:151], a[32:35]
  ds_read_b64_tr_b16 v[76:77], v32 offset:0
  v_mfma_f32_16x16x32_bf16 a[36:39], v[96:99], v[148:151], a[36:39]
  ds_read_b64_tr_b16 v[78:79], v32 offset:1024
  buffer_load_dwordx4 v[144:147], v39, s[48:51], s75 offen offset:0 sc1
  v_mfma_f32_16x16x32_bf16 a[40:43], v[100:103], v[148:151], a[40:43]
  ds_read_b64_tr_b16 v[80:81], v33 offset:0
  v_mfma_f32_16x16x32_bf16 a[44:47], v[104:107], v[148:151], a[44:47]
  ds_read_b64_tr_b16 v[82:83], v33 offset:1024
  s_waitcnt vmcnt(18)
  v_mfma_f32_16x16x32_bf16 a[48:51], v[92:95], v[152:155], a[48:51]
  ds_read_b64_tr_b16 v[84:85], v34 offset:0
  v_mfma_f32_16x16x32_bf16 a[52:55], v[96:99], v[152:155], a[52:55]
  ds_read_b64_tr_b16 v[86:87], v34 offset:1024
  buffer_load_dwordx4 v[148:151], v39, s[48:51], s76 offen offset:0 sc1
  v_mfma_f32_16x16x32_bf16 a[56:59], v[100:103], v[152:155], a[56:59]
  ds_read_b64_tr_b16 v[88:89], v35 offset:0
  v_mfma_f32_16x16x32_bf16 a[60:63], v[104:107], v[152:155], a[60:63]
  ds_read_b64_tr_b16 v[90:91], v35 offset:1024
  s_waitcnt vmcnt(18)
  v_mfma_f32_16x16x32_bf16 a[0:3], v[92:95], v[140:143], a[0:3]
  v_mfma_f32_16x16x32_bf16 a[4:7], v[96:99], v[140:143], a[4:7]
  buffer_load_dwordx4 v[152:155], v39, s[48:51], s77 offen offset:0 sc1
  v_mfma_f32_16x16x32_bf16 a[8:11], v[100:103], v[140:143], a[8:11]
  v_mfma_f32_16x16x32_bf16 a[12:15], v[104:107], v[140:143], a[12:15]
  buffer_load_dwordx4 v[140:143], v39, s[48:51], s74 offen offset:0 sc1
  s_waitcnt lgkmcnt(15)
  s_waitcnt vmcnt(19)
  v_mfma_f32_16x16x32_bf16 a[16:19], v[44:47], v[160:163], a[16:19]
  v_mfma_f32_16x16x32_bf16 a[20:23], v[48:51], v[160:163], a[20:23]
  v_mfma_f32_16x16x32_bf16 a[24:27], v[52:55], v[160:163], a[24:27]
  v_mfma_f32_16x16x32_bf16 a[28:31], v[56:59], v[160:163], a[28:31]
  s_waitcnt vmcnt(18)
  v_mfma_f32_16x16x32_bf16 a[32:35], v[44:47], v[164:167], a[32:35]
  ds_read_b64_tr_b16 v[92:93], v32 offset:4096
  v_mfma_f32_16x16x32_bf16 a[36:39], v[48:51], v[164:167], a[36:39]
  ds_read_b64_tr_b16 v[94:95], v32 offset:5120
  buffer_load_dwordx4 v[160:163], v39, s[48:51], s75 offen offset:1024 sc1
  v_mfma_f32_16x16x32_bf16 a[40:43], v[52:55], v[164:167], a[40:43]
  ds_read_b64_tr_b16 v[96:97], v33 offset:4096
  v_mfma_f32_16x16x32_bf16 a[44:47], v[56:59], v[164:167], a[44:47]
  ds_read_b64_tr_b16 v[98:99], v33 offset:5120
  s_waitcnt vmcnt(18)
  v_mfma_f32_16x16x32_bf16 a[48:51], v[44:47], v[168:171], a[48:51]
  ds_read_b64_tr_b16 v[100:101], v34 offset:4096
  v_mfma_f32_16x16x32_bf16 a[52:55], v[48:51], v[168:171], a[52:55]
  ds_read_b64_tr_b16 v[102:103], v34 offset:5120
  buffer_load_dwordx4 v[164:167], v39, s[48:51], s76 offen offset:1024 sc1
  v_mfma_f32_16x16x32_bf16 a[56:59], v[52:55], v[168:171], a[56:59]
  ds_read_b64_tr_b16 v[104:105], v35 offset:4096
  v_mfma_f32_16x16x32_bf16 a[60:63], v[56:59], v[168:171], a[60:63]
  ds_read_b64_tr_b16 v[106:107], v35 offset:5120
  s_waitcnt vmcnt(18)
  v_mfma_f32_16x16x32_bf16 a[0:3], v[44:47], v[156:159], a[0:3]
  v_mfma_f32_16x16x32_bf16 a[4:7], v[48:51], v[156:159], a[4:7]
  buffer_load_dwordx4 v[168:171], v39, s[48:51], s77 offen offset:1024 sc1
  v_mfma_f32_16x16x32_bf16 a[8:11], v[52:55], v[156:159], a[8:11]
  v_mfma_f32_16x16x32_bf16 a[12:15], v[56:59], v[156:159], a[12:15]
  buffer_load_dwordx4 v[156:159], v39, s[48:51], s74 offen offset:1024 sc1
  s_waitcnt lgkmcnt(15)
  s_waitcnt vmcnt(19)
  v_mfma_f32_16x16x32_bf16 a[16:19], v[60:63], v[176:179], a[16:19]
  v_mfma_f32_16x16x32_bf16 a[20:23], v[64:67], v[176:179], a[20:23]
  v_mfma_f32_16x16x32_bf16 a[24:27], v[68:71], v[176:179], a[24:27]
  v_mfma_f32_16x16x32_bf16 a[28:31], v[72:75], v[176:179], a[28:31]
  s_waitcnt vmcnt(18)
  v_mfma_f32_16x16x32_bf16 a[32:35], v[60:63], v[180:183], a[32:35]
  ds_read_b64_tr_b16 v[44:45], v32 offset:8192
  v_mfma_f32_16x16x32_bf16 a[36:39], v[64:67], v[180:183], a[36:39]
  ds_read_b64_tr_b16 v[46:47], v32 offset:9216
  v_mfma_f32_16x16x32_bf16 a[40:43], v[68:71], v[180:183], a[40:43]
  ds_read_b64_tr_b16 v[48:49], v33 offset:8192
  v_mfma_f32_16x16x32_bf16 a[44:47], v[72:75], v[180:183], a[44:47]
  ds_read_b64_tr_b16 v[50:51], v33 offset:9216
  s_waitcnt vmcnt(17)
  v_mfma_f32_16x16x32_bf16 a[48:51], v[60:63], v[184:187], a[48:51]
  ds_read_b64_tr_b16 v[52:53], v34 offset:8192
  v_mfma_f32_16x16x32_bf16 a[52:55], v[64:67], v[184:187], a[52:55]
  ds_read_b64_tr_b16 v[54:55], v34 offset:9216
  v_mfma_f32_16x16x32_bf16 a[56:59], v[68:71], v[184:187], a[56:59]
  ds_read_b64_tr_b16 v[56:57], v35 offset:8192
  v_mfma_f32_16x16x32_bf16 a[60:63], v[72:75], v[184:187], a[60:63]
  ds_read_b64_tr_b16 v[58:59], v35 offset:9216
  s_waitcnt vmcnt(16)
  v_mfma_f32_16x16x32_bf16 a[0:3], v[60:63], v[172:175], a[0:3]
  v_mfma_f32_16x16x32_bf16 a[4:7], v[64:67], v[172:175], a[4:7]
  v_mfma_f32_16x16x32_bf16 a[8:11], v[68:71], v[172:175], a[8:11]
  v_mfma_f32_16x16x32_bf16 a[12:15], v[72:75], v[172:175], a[12:15]
  s_waitcnt lgkmcnt(15)
  s_waitcnt vmcnt(15)
  v_mfma_f32_16x16x32_bf16 a[16:19], v[76:79], v[112:115], a[16:19]
  v_mfma_f32_16x16x32_bf16 a[20:23], v[80:83], v[112:115], a[20:23]
  v_mfma_f32_16x16x32_bf16 a[24:27], v[84:87], v[112:115], a[24:27]
  v_mfma_f32_16x16x32_bf16 a[28:31], v[88:91], v[112:115], a[28:31]
  s_waitcnt vmcnt(14)
  v_mfma_f32_16x16x32_bf16 a[32:35], v[76:79], v[116:119], a[32:35]
  ds_read_b64_tr_b16 v[60:61], v32 offset:12288
  v_mfma_f32_16x16x32_bf16 a[36:39], v[80:83], v[116:119], a[36:39]
  ds_read_b64_tr_b16 v[62:63], v32 offset:13312
  v_mfma_f32_16x16x32_bf16 a[40:43], v[84:87], v[116:119], a[40:43]
  ds_read_b64_tr_b16 v[64:65], v33 offset:12288
  v_mfma_f32_16x16x32_bf16 a[44:47], v[88:91], v[116:119], a[44:47]
  ds_read_b64_tr_b16 v[66:67], v33 offset:13312
  s_waitcnt vmcnt(13)
  v_mfma_f32_16x16x32_bf16 a[48:51], v[76:79], v[120:123], a[48:51]
  ds_read_b64_tr_b16 v[68:69], v34 offset:12288
  v_mfma_f32_16x16x32_bf16 a[52:55], v[80:83], v[120:123], a[52:55]
  ds_read_b64_tr_b16 v[70:71], v34 offset:13312
  v_mfma_f32_16x16x32_bf16 a[56:59], v[84:87], v[120:123], a[56:59]
  ds_read_b64_tr_b16 v[72:73], v35 offset:12288
  v_mfma_f32_16x16x32_bf16 a[60:63], v[88:91], v[120:123], a[60:63]
  ds_read_b64_tr_b16 v[74:75], v35 offset:13312
  s_waitcnt vmcnt(12)
  v_mfma_f32_16x16x32_bf16 a[0:3], v[76:79], v[108:111], a[0:3]
  v_mfma_f32_16x16x32_bf16 a[4:7], v[80:83], v[108:111], a[4:7]
  v_mfma_f32_16x16x32_bf16 a[8:11], v[84:87], v[108:111], a[8:11]
  v_mfma_f32_16x16x32_bf16 a[12:15], v[88:91], v[108:111], a[12:15]
  s_waitcnt lgkmcnt(15)
  s_waitcnt vmcnt(11)
  v_mfma_f32_16x16x32_bf16 a[16:19], v[92:95], v[128:131], a[16:19]
  v_mfma_f32_16x16x32_bf16 a[20:23], v[96:99], v[128:131], a[20:23]
  v_mfma_f32_16x16x32_bf16 a[24:27], v[100:103], v[128:131], a[24:27]
  v_mfma_f32_16x16x32_bf16 a[28:31], v[104:107], v[128:131], a[28:31]
  s_waitcnt vmcnt(10)
  v_mfma_f32_16x16x32_bf16 a[32:35], v[92:95], v[132:135], a[32:35]
  v_mfma_f32_16x16x32_bf16 a[36:39], v[96:99], v[132:135], a[36:39]
  v_mfma_f32_16x16x32_bf16 a[40:43], v[100:103], v[132:135], a[40:43]
  v_mfma_f32_16x16x32_bf16 a[44:47], v[104:107], v[132:135], a[44:47]
  s_waitcnt vmcnt(9)
  v_mfma_f32_16x16x32_bf16 a[48:51], v[92:95], v[136:139], a[48:51]
  v_mfma_f32_16x16x32_bf16 a[52:55], v[96:99], v[136:139], a[52:55]
  v_mfma_f32_16x16x32_bf16 a[56:59], v[100:103], v[136:139], a[56:59]
  v_mfma_f32_16x16x32_bf16 a[60:63], v[104:107], v[136:139], a[60:63]
  s_waitcnt vmcnt(8)
  v_mfma_f32_16x16x32_bf16 a[0:3], v[92:95], v[124:127], a[0:3]
  v_mfma_f32_16x16x32_bf16 a[4:7], v[96:99], v[124:127], a[4:7]
  v_mfma_f32_16x16x32_bf16 a[8:11], v[100:103], v[124:127], a[8:11]
  v_mfma_f32_16x16x32_bf16 a[12:15], v[104:107], v[124:127], a[12:15]
  s_waitcnt lgkmcnt(8)
  s_waitcnt vmcnt(7)
  v_mfma_f32_16x16x32_bf16 a[16:19], v[44:47], v[144:147], a[16:19]
  v_mfma_f32_16x16x32_bf16 a[20:23], v[48:51], v[144:147], a[20:23]
  v_mfma_f32_16x16x32_bf16 a[24:27], v[52:55], v[144:147], a[24:27]
  v_mfma_f32_16x16x32_bf16 a[28:31], v[56:59], v[144:147], a[28:31]
  s_waitcnt vmcnt(6)
  v_mfma_f32_16x16x32_bf16 a[32:35], v[44:47], v[148:151], a[32:35]
  v_mfma_f32_16x16x32_bf16 a[36:39], v[48:51], v[148:151], a[36:39]
  v_mfma_f32_16x16x32_bf16 a[40:43], v[52:55], v[148:151], a[40:43]
  v_mfma_f32_16x16x32_bf16 a[44:47], v[56:59], v[148:151], a[44:47]
  s_waitcnt vmcnt(5)
  v_mfma_f32_16x16x32_bf16 a[48:51], v[44:47], v[152:155], a[48:51]
  v_mfma_f32_16x16x32_bf16 a[52:55], v[48:51], v[152:155], a[52:55]
  v_mfma_f32_16x16x32_bf16 a[56:59], v[52:55], v[152:155], a[56:59]
  v_mfma_f32_16x16x32_bf16 a[60:63], v[56:59], v[152:155], a[60:63]
  s_waitcnt vmcnt(4)
  v_mfma_f32_16x16x32_bf16 a[0:3], v[44:47], v[140:143], a[0:3]
  v_mfma_f32_16x16x32_bf16 a[4:7], v[48:51], v[140:143], a[4:7]
  v_mfma_f32_16x16x32_bf16 a[8:11], v[52:55], v[140:143], a[8:11]
  v_mfma_f32_16x16x32_bf16 a[12:15], v[56:59], v[140:143], a[12:15]
  s_waitcnt lgkmcnt(0)
  s_waitcnt vmcnt(3)
  v_mfma_f32_16x16x32_bf16 a[16:19], v[60:63], v[160:163], a[16:19]
  v_mfma_f32_16x16x32_bf16 a[20:23], v[64:67], v[160:163], a[20:23]
  v_mfma_f32_16x16x32_bf16 a[24:27], v[68:71], v[160:163], a[24:27]
  v_mfma_f32_16x16x32_bf16 a[28:31], v[72:75], v[160:163], a[28:31]
  s_waitcnt vmcnt(2)
  v_mfma_f32_16x16x32_bf16 a[32:35], v[60:63], v[164:167], a[32:35]
  v_mfma_f32_16x16x32_bf16 a[36:39], v[64:67], v[164:167], a[36:39]
  v_mfma_f32_16x16x32_bf16 a[40:43], v[68:71], v[164:167], a[40:43]
  s_nop 0
  ds_write_b128 v27, a[16:19] offset:0
  v_mfma_f32_16x16x32_bf16 a[44:47], v[72:75], v[164:167], a[44:47]
  ds_write_b128 v27, a[20:23] offset:1024
  s_waitcnt vmcnt(1)
  v_mfma_f32_16x16x32_bf16 a[48:51], v[60:63], v[168:171], a[48:51]
  ds_write_b128 v27, a[24:27] offset:2048
  v_mfma_f32_16x16x32_bf16 a[52:55], v[64:67], v[168:171], a[52:55]
  ds_write_b128 v27, a[28:31] offset:3072
  v_mfma_f32_16x16x32_bf16 a[56:59], v[68:71], v[168:171], a[56:59]
  ds_write_b128 v27, a[32:35] offset:4096
  v_mfma_f32_16x16x32_bf16 a[60:63], v[72:75], v[168:171], a[60:63]
  ds_write_b128 v27, a[36:39] offset:5120
  s_waitcnt vmcnt(0)
  v_mfma_f32_16x16x32_bf16 a[0:3], v[60:63], v[156:159], a[0:3]
  ds_write_b128 v27, a[40:43] offset:6144
  v_mfma_f32_16x16x32_bf16 a[4:7], v[64:67], v[156:159], a[4:7]
  ds_write_b128 v27, a[44:47] offset:7168
  v_mfma_f32_16x16x32_bf16 a[8:11], v[68:71], v[156:159], a[8:11]
  ds_write_b128 v27, a[48:51] offset:8192
  v_mfma_f32_16x16x32_bf16 a[12:15], v[72:75], v[156:159], a[12:15]
  ds_write_b128 v27, a[52:55] offset:9216
  ds_write_b128 v27, a[56:59] offset:10240
  ds_write_b128 v27, a[60:63] offset:11264
  v_accvgpr_read_b32 v44, a0
  v_accvgpr_read_b32 v45, a1
  v_accvgpr_read_b32 v46, a2
  v_accvgpr_read_b32 v47, a3
  v_accvgpr_read_b32 v48, a4
  v_accvgpr_read_b32 v49, a5
  v_accvgpr_read_b32 v50, a6
  v_accvgpr_read_b32 v51, a7
  v_accvgpr_read_b32 v52, a8
  v_accvgpr_read_b32 v53, a9
  v_accvgpr_read_b32 v54, a10
  v_accvgpr_read_b32 v55, a11
  v_accvgpr_read_b32 v56, a12
  v_accvgpr_read_b32 v57, a13
  v_accvgpr_read_b32 v58, a14
  v_accvgpr_read_b32 v59, a15
  s_waitcnt lgkmcnt(0)
  s_barrier
  ds_read_b128 v[108:111], v24 offset:0
  ds_read_b128 v[112:115], v24 offset:1024
  ds_read_b128 v[116:119], v24 offset:2048
  ds_read_b128 v[120:123], v24 offset:3072
  ds_read_b128 v[124:127], v25 offset:4096
  ds_read_b128 v[128:131], v25 offset:5120
  ds_read_b128 v[132:135], v25 offset:6144
  ds_read_b128 v[136:139], v25 offset:7168
  ds_read_b128 v[140:143], v26 offset:8192
  ds_read_b128 v[144:147], v26 offset:9216
  ds_read_b128 v[148:151], v26 offset:10240
  ds_read_b128 v[152:155], v26 offset:11264
  v_lshlrev_b32 v76, 16, v12
  v_and_b32 v77, s69, v12
  v_lshlrev_b32 v78, 16, v13
  v_and_b32 v79, s69, v13
  v_lshlrev_b32 v80, 16, v14
  v_and_b32 v81, s69, v14
  v_lshlrev_b32 v82, 16, v15
  v_and_b32 v83, s69, v15
  v_lshlrev_b32 v84, 16, v16
  v_and_b32 v85, s69, v16
  v_lshlrev_b32 v86, 16, v17
  v_and_b32 v87, s69, v17
  v_lshlrev_b32 v88, 16, v18
  v_and_b32 v89, s69, v18
  v_lshlrev_b32 v90, 16, v19
  v_and_b32 v91, s69, v19
  s_waitcnt lgkmcnt(11)
  v_pk_add_f32 v[44:45], v[44:45], v[108:109]
  v_pk_add_f32 v[46:47], v[46:47], v[110:111]
  s_waitcnt lgkmcnt(10)
  v_pk_add_f32 v[48:49], v[48:49], v[112:113]
  v_pk_add_f32 v[50:51], v[50:51], v[114:115]
  s_waitcnt lgkmcnt(9)
  v_pk_add_f32 v[52:53], v[52:53], v[116:117]
  v_pk_add_f32 v[54:55], v[54:55], v[118:119]
  s_waitcnt lgkmcnt(8)
  v_pk_add_f32 v[56:57], v[56:57], v[120:121]
  v_pk_add_f32 v[58:59], v[58:59], v[122:123]
  s_waitcnt lgkmcnt(7)
  v_pk_add_f32 v[44:45], v[44:45], v[124:125]
  v_pk_add_f32 v[46:47], v[46:47], v[126:127]
  s_waitcnt lgkmcnt(6)
  v_pk_add_f32 v[48:49], v[48:49], v[128:129]
  v_pk_add_f32 v[50:51], v[50:51], v[130:131]
  s_waitcnt lgkmcnt(5)
  v_pk_add_f32 v[52:53], v[52:53], v[132:133]
  v_pk_add_f32 v[54:55], v[54:55], v[134:135]
  s_waitcnt lgkmcnt(4)
  v_pk_add_f32 v[56:57], v[56:57], v[136:137]
  v_pk_add_f32 v[58:59], v[58:59], v[138:139]
  s_waitcnt lgkmcnt(3)
  v_pk_add_f32 v[44:45], v[44:45], v[140:141]
  v_pk_add_f32 v[46:47], v[46:47], v[142:143]
  s_waitcnt lgkmcnt(2)
  v_pk_add_f32 v[48:49], v[48:49], v[144:145]
  v_pk_add_f32 v[50:51], v[50:51], v[146:147]
  s_waitcnt lgkmcnt(1)
  v_pk_add_f32 v[52:53], v[52:53], v[148:149]
  v_pk_add_f32 v[54:55], v[54:55], v[150:151]
  s_waitcnt lgkmcnt(0)
  v_pk_add_f32 v[56:57], v[56:57], v[152:153]
  v_pk_add_f32 v[58:59], v[58:59], v[154:155]
  v_pk_add_f32 v[76:77], v[76:77], v[44:45]
  v_cvt_pk_bf16_f32 v60, v76, v77
  v_pk_add_f32 v[78:79], v[78:79], v[46:47]
  v_cvt_pk_bf16_f32 v61, v78, v79
  ds_write_b64 v20, v[60:61]
  v_pk_add_f32 v[80:81], v[80:81], v[48:49]
  v_cvt_pk_bf16_f32 v62, v80, v81
  v_pk_add_f32 v[82:83], v[82:83], v[50:51]
  v_cvt_pk_bf16_f32 v63, v82, v83
  ds_write_b64 v21, v[62:63]
  v_pk_add_f32 v[84:85], v[84:85], v[52:53]
  v_cvt_pk_bf16_f32 v64, v84, v85
  v_pk_add_f32 v[86:87], v[86:87], v[54:55]
  v_cvt_pk_bf16_f32 v65, v86, v87
  ds_write_b64 v22, v[64:65]
  v_pk_add_f32 v[88:89], v[88:89], v[56:57]
  v_cvt_pk_bf16_f32 v66, v88, v89
  v_pk_add_f32 v[90:91], v[90:91], v[58:59]
  v_cvt_pk_bf16_f32 v67, v90, v91
  ds_write_b64 v23, v[66:67]
  ds_read_b128 v[68:71], v10 offset:0
  ds_read_b128 v[72:75], v10 offset:1024
  s_waitcnt lgkmcnt(1)
  buffer_store_dwordx4 v[68:71], v11, s[44:47], s94 offen
  s_waitcnt lgkmcnt(0)
  buffer_store_dwordx4 v[72:75], v11, s[44:47], s95 offen
L_end:
  s_endpgm
L_loader:
  s_lshl_b32 s63, s56, 7
  s_lshl_b32 s64, s58, 5
  s_add_u32 s64, s64, s63
  s_lshl_b32 s94, s64, 10
  v_lshrrev_b32 v4, 3, v1
  v_and_b32 v5, 7, v1
  v_xor_b32 v5, v5, v3
  v_lshlrev_b32 v6, 11, v4
  v_lshl_add_u32 v10, v5, 4, v6
  v_xor_b32 v11, 64, v10
  v_add_u32 v11, 14336, v11
  s_and_b32 s64, s58, 1
  s_add_u32 s63, s63, s64
  s_sub_u32 s63, s63, 16
  v_lshl_add_u32 v7, v4, 1, s63
  v_max_i32 v7, 0, v7
  v_lshlrev_b32 v7, 10, v7
  s_lshl_b32 s64, s64, 2
  v_xor_b32 v5, s64, v5
  v_lshl_add_u32 v12, v5, 4, v7
  s_lshr_b32 s95, s58, 1
  s_lshl_b32 s95, s95, 7
  v_lshrrev_b32 v4, 2, v1
  v_mul_u32_u24 v4, 3072, v4
  v_lshrrev_b32 v5, 5, v1
  v_lshlrev_b32 v5, 1, v5
  v_and_b32 v6, 3, v1
  v_xor_b32 v5, v5, v6
  v_lshl_add_u32 v13, v5, 4, v4
  s_mul_i32 s67, s58, 49152
  s_lshl_b32 s63, s57, 6
  s_add_u32 s67, s67, s63
  s_mul_i32 s68, s58, 3072
  s_lshl_b32 s96, s58, 12
  s_lshl_b32 s73, s58, 10
  v_lshrrev_b32 v4, 3, v1
  v_lshlrev_b32 v4, 10, v4
  v_lshlrev_b32 v5, 1, v3
  v_and_b32 v6, 7, v1
  v_xor_b32 v5, v5, v6
  v_lshl_add_u32 v14, v5, 4, v4
  s_lshl_b32 s63, s60, 7
  s_lshl_b32 s72, s58, 13
  s_add_u32 s72, s72, s63
  s_waitcnt lgkmcnt(0)
  s_mov_b32 s24, s4
  s_and_b32 s25, s5, 0xffff
  s_mov_b32 s26, 2097152
  s_mov_b32 s27, 0x20000
  s_mov_b32 s28, s6
  s_and_b32 s29, s7, 0xffff
  s_mov_b32 s30, 1572864
  s_mov_b32 s31, 0x20000
  s_mov_b32 s48, s22
  s_and_b32 s49, s23, 0xffff
  s_mov_b32 s50, 16777216
  s_mov_b32 s51, 0x20000
  s_add_u32 m0, s96, 98304
  s_add_u32 s65, s94, 0
  buffer_load_dwordx4 v10, s[24:27], s65 offen lds
  buffer_load_dwordx4 v10, s[24:27], s65 offen offset:1024 lds
  buffer_load_dwordx4 v11, s[24:27], s65 offen offset:2048 lds
  buffer_load_dwordx4 v11, s[24:27], s65 offen offset:3072 lds
  s_add_u32 m0, s73, 147456
  s_add_u32 s65, s95, 0
  buffer_load_dwordx4 v12, s[24:27], s65 offen lds
  s_add_u32 m0, s68, 0
  s_add_u32 s65, s67, 0
  buffer_load_dwordx4 v13, s[28:31], s65 offen lds
  buffer_load_dwordx4 v13, s[28:31], s65 offen offset:1024 lds
  buffer_load_dwordx4 v13, s[28:31], s65 offen offset:2048 lds
  s_add_u32 m0, s96, 114688
  s_add_u32 s65, s94, 128
  buffer_load_dwordx4 v10, s[24:27], s65 offen lds
  buffer_load_dwordx4 v10, s[24:27], s65 offen offset:1024 lds
  buffer_load_dwordx4 v11, s[24:27], s65 offen offset:2048 lds
  buffer_load_dwordx4 v11, s[24:27], s65 offen offset:3072 lds
  s_add_u32 m0, s68, 12288
  s_add_u32 s65, s67, 196608
  buffer_load_dwordx4 v13, s[28:31], s65 offen lds
  buffer_load_dwordx4 v13, s[28:31], s65 offen offset:1024 lds
  buffer_load_dwordx4 v13, s[28:31], s65 offen offset:2048 lds
  s_or_b32 s63, s2, s58
  s_cmp_lg_u32 s63, 0
  s_cbranch_scc1 L_nl_done
  v_lshlrev_b32 v4, 7, v1
  s_mov_b32 s63, 524288
  buffer_load_dwordx4 v[24:27], v4, s[48:51], s63 offen sc1
  s_mov_b32 s63, 532480
  buffer_load_dwordx4 v[28:31], v4, s[48:51], s63 offen sc1
  s_mov_b32 s63, 540672
  buffer_load_dwordx4 v[32:35], v4, s[48:51], s63 offen sc1
  s_mov_b32 s63, 548864
  buffer_load_dwordx4 v[36:39], v4, s[48:51], s63 offen sc1
L_nl_done:
  s_mov_b32 s32, s8
  s_and_b32 s33, s9, 0xffff
  s_mov_b32 s34, 524288
  s_mov_b32 s35, 0x20000
  s_mov_b32 s40, s16
  s_and_b32 s41, s17, 0xffff
  s_mov_b32 s42, 1835008
  s_mov_b32 s43, 0x20000
  s_mov_b32 s52, s20
  s_and_b32 s53, s21, 0xffff
  s_mov_b32 s54, 256
  s_mov_b32 s55, 0x20000
  s_bitcmp1_b32 s58, 0
  s_cselect_b32 s36, s14, s12
  s_cselect_b32 s37, s15, s13
  s_and_b32 s37, s37, 0xffff
  s_mov_b32 s38, 1835008
  s_mov_b32 s39, 0x20000
  s_mov_b32 s63, 4682
  v_add_u32 v4, 0, v1
  v_mul_u32_u24 v5, s63, v4
  v_lshrrev_b32 v5, 16, v5
  v_mul_u32_u24 v6, 3360, v5
  v_lshl_add_u32 v16, v4, 4, v6
  v_add_u32 v4, 64, v1
  v_mul_u32_u24 v5, s63, v4
  v_lshrrev_b32 v5, 16, v5
  v_mul_u32_u24 v6, 3360, v5
  v_lshl_add_u32 v17, v4, 4, v6
  v_subrev_u32 v17, 1024, v17
  v_add_u32 v4, 128, v1
  v_mul_u32_u24 v5, s63, v4
  v_lshrrev_b32 v5, 16, v5
  v_mul_u32_u24 v6, 3360, v5
  v_lshl_add_u32 v18, v4, 4, v6
  v_subrev_u32 v18, 2048, v18
  v_add_u32 v4, 192, v1
  v_mul_u32_u24 v5, s63, v4
  v_lshrrev_b32 v5, 16, v5
  v_mul_u32_u24 v6, 3360, v5
  v_lshl_add_u32 v19, v4, 4, v6
  v_subrev_u32 v19, 3072, v19
  v_add_u32 v4, 256, v1
  v_mul_u32_u24 v5, s63, v4
  v_lshrrev_b32 v5, 16, v5
  v_mul_u32_u24 v6, 3360, v5
  v_lshl_add_u32 v20, v4, 4, v6
  v_add_u32 v4, 320, v1
  v_mul_u32_u24 v5, s63, v4
  v_lshrrev_b32 v5, 16, v5
  v_mul_u32_u24 v6, 3360, v5
  v_lshl_add_u32 v21, v4, 4, v6
  v_subrev_u32 v21, 1024, v21
  v_add_u32 v4, 384, v1
  v_mul_u32_u24 v5, s63, v4
  v_lshrrev_b32 v5, 16, v5
  v_mul_u32_u24 v6, 3360, v5
  v_lshl_add_u32 v22, v4, 4, v6
  v_subrev_u32 v22, 2048, v22
  s_lshr_b32 s63, s58, 1
  s_mul_i32 s70, s63, 114688
  s_mul_i32 s64, s101, 224
  s_add_u32 s70, s70, s64
  s_mul_i32 s71, s63, 14464
  s_and_b32 s63, s58, 1
  s_mul_i32 s65, s63, 7296
  s_add_u32 s71, s71, s65
  s_mul_i32 s99, s63, 7296
  s_add_u32 s99, s99, 0
  s_mul_i32 s98, s100, 114688
  s_add_u32 s98, s98, s64
  s_mov_b32 s76, s12
  s_and_b32 s77, s13, 0xffff
  s_mov_b32 s78, 1835008
  s_mov_b32 s79, 0x20000
  s_mov_b32 s80, s14
  s_and_b32 s81, s15, 0xffff
  s_mov_b32 s82, 1835008
  s_mov_b32 s83, 0x20000
  s_lshr_b32 s63, s2, 3
  s_lshl_b32 s63, s63, 2
  s_add_u32 s63, s63, s58
  s_lshl_b32 s63, s63, 13
  v_lshl_add_u32 v40, v1, 7, s63
  s_waitcnt vmcnt(7)
  s_barrier
  s_add_u32 m0, s96, 131072
  s_add_u32 s65, s94, 256
  buffer_load_dwordx4 v10, s[24:27], s65 offen lds
  buffer_load_dwordx4 v10, s[24:27], s65 offen offset:1024 lds
  buffer_load_dwordx4 v11, s[24:27], s65 offen offset:2048 lds
  buffer_load_dwordx4 v11, s[24:27], s65 offen offset:3072 lds
  s_add_u32 m0, s73, 151552
  s_add_u32 s65, s95, 256
  buffer_load_dwordx4 v12, s[24:27], s65 offen lds
  s_add_u32 m0, s68, 24576
  s_add_u32 s65, s67, 393216
  buffer_load_dwordx4 v13, s[28:31], s65 offen lds
  buffer_load_dwordx4 v13, s[28:31], s65 offen offset:1024 lds
  buffer_load_dwordx4 v13, s[28:31], s65 offen offset:2048 lds
  s_waitcnt vmcnt(8)
  s_barrier
  s_add_u32 m0, s96, 98304
  s_add_u32 s65, s94, 384
  buffer_load_dwordx4 v10, s[24:27], s65 offen lds
  buffer_load_dwordx4 v10, s[24:27], s65 offen offset:1024 lds
  buffer_load_dwordx4 v11, s[24:27], s65 offen offset:2048 lds
  buffer_load_dwordx4 v11, s[24:27], s65 offen offset:3072 lds
  s_add_u32 m0, s68, 36864
  s_add_u32 s65, s67, 589824
  buffer_load_dwordx4 v13, s[28:31], s65 offen lds
  buffer_load_dwordx4 v13, s[28:31], s65 offen offset:1024 lds
  buffer_load_dwordx4 v13, s[28:31], s65 offen offset:2048 lds
  s_waitcnt vmcnt(7)
  s_barrier
  s_add_u32 m0, s96, 114688
  s_add_u32 s65, s94, 512
  buffer_load_dwordx4 v10, s[24:27], s65 offen lds
  buffer_load_dwordx4 v10, s[24:27], s65 offen offset:1024 lds
  buffer_load_dwordx4 v11, s[24:27], s65 offen offset:2048 lds
  buffer_load_dwordx4 v11, s[24:27], s65 offen offset:3072 lds
  s_add_u32 m0, s73, 155648
  s_add_u32 s65, s95, 512
  buffer_load_dwordx4 v12, s[24:27], s65 offen lds
  s_add_u32 m0, s68, 49152
  s_add_u32 s65, s67, 786432
  buffer_load_dwordx4 v13, s[28:31], s65 offen lds
  buffer_load_dwordx4 v13, s[28:31], s65 offen offset:1024 lds
  buffer_load_dwordx4 v13, s[28:31], s65 offen offset:2048 lds
  s_or_b32 s63, s2, s58
  s_cmp_lg_u32 s63, 0
  s_cbranch_scc1 L_nonce_done
  s_mov_b32 s59, 0
L_nonce_loop:
  s_add_u32 s59, s59, 1
  s_mov_b64 s[86:87], 0
  v_cmp_eq_u32 vcc, s59, v24
  s_nop 1
  s_or_b64 s[86:87], s[86:87], vcc
  v_cmp_eq_u32 vcc, s59, v25
  s_nop 1
  s_or_b64 s[86:87], s[86:87], vcc
  v_cmp_eq_u32 vcc, s59, v26
  s_nop 1
  s_or_b64 s[86:87], s[86:87], vcc
  v_cmp_eq_u32 vcc, s59, v27
  s_nop 1
  s_or_b64 s[86:87], s[86:87], vcc
  v_cmp_eq_u32 vcc, s59, v28
  s_nop 1
  s_or_b64 s[86:87], s[86:87], vcc
  v_cmp_eq_u32 vcc, s59, v29
  s_nop 1
  s_or_b64 s[86:87], s[86:87], vcc
  v_cmp_eq_u32 vcc, s59, v30
  s_nop 1
  s_or_b64 s[86:87], s[86:87], vcc
  v_cmp_eq_u32 vcc, s59, v31
  s_nop 1
  s_or_b64 s[86:87], s[86:87], vcc
  v_cmp_eq_u32 vcc, s59, v32
  s_nop 1
  s_or_b64 s[86:87], s[86:87], vcc
  v_cmp_eq_u32 vcc, s59, v33
  s_nop 1
  s_or_b64 s[86:87], s[86:87], vcc
  v_cmp_eq_u32 vcc, s59, v34
  s_nop 1
  s_or_b64 s[86:87], s[86:87], vcc
  v_cmp_eq_u32 vcc, s59, v35
  s_nop 1
  s_or_b64 s[86:87], s[86:87], vcc
  v_cmp_eq_u32 vcc, s59, v36
  s_nop 1
  s_or_b64 s[86:87], s[86:87], vcc
  v_cmp_eq_u32 vcc, s59, v37
  s_nop 1
  s_or_b64 s[86:87], s[86:87], vcc
  v_cmp_eq_u32 vcc, s59, v38
  s_nop 1
  s_or_b64 s[86:87], s[86:87], vcc
  v_cmp_eq_u32 vcc, s59, v39
  s_nop 1
  s_or_b64 s[86:87], s[86:87], vcc
  s_cmp_lg_u64 s[86:87], 0
  s_cbranch_scc1 L_nonce_loop
  v_mov_b32 v4, 0
  v_mov_b32 v5, s59
  s_mov_b64 exec, 1
  buffer_store_dword v5, v4, s[52:55], 0 offen sc1
  s_mov_b64 exec, -1
L_nonce_done:
  s_waitcnt vmcnt(8)
  s_barrier
  s_add_u32 m0, s96, 131072
  s_add_u32 s65, s94, 640
  buffer_load_dwordx4 v10, s[24:27], s65 offen lds
  buffer_load_dwordx4 v10, s[24:27], s65 offen offset:1024 lds
  buffer_load_dwordx4 v11, s[24:27], s65 offen offset:2048 lds
  buffer_load_dwordx4 v11, s[24:27], s65 offen offset:3072 lds
  s_add_u32 m0, s68, 61440
  s_add_u32 s65, s67, 983040
  buffer_load_dwordx4 v13, s[28:31], s65 offen lds
  buffer_load_dwordx4 v13, s[28:31], s65 offen offset:1024 lds
  buffer_load_dwordx4 v13, s[28:31], s65 offen offset:2048 lds
  s_waitcnt vmcnt(7)
  s_barrier
  s_add_u32 m0, s96, 98304
  s_add_u32 s65, s94, 768
  buffer_load_dwordx4 v10, s[24:27], s65 offen lds
  buffer_load_dwordx4 v10, s[24:27], s65 offen offset:1024 lds
  buffer_load_dwordx4 v11, s[24:27], s65 offen offset:2048 lds
  buffer_load_dwordx4 v11, s[24:27], s65 offen offset:3072 lds
  s_add_u32 m0, s73, 159744
  s_add_u32 s65, s95, 768
  buffer_load_dwordx4 v12, s[24:27], s65 offen lds
  s_add_u32 m0, s68, 73728
  s_add_u32 s65, s67, 1179648
  buffer_load_dwordx4 v13, s[28:31], s65 offen lds
  buffer_load_dwordx4 v13, s[28:31], s65 offen offset:1024 lds
  buffer_load_dwordx4 v13, s[28:31], s65 offen offset:2048 lds
  s_waitcnt vmcnt(8)
  s_barrier
  s_add_u32 m0, s96, 114688
  s_add_u32 s65, s94, 896
  buffer_load_dwordx4 v10, s[24:27], s65 offen lds
  buffer_load_dwordx4 v10, s[24:27], s65 offen offset:1024 lds
  buffer_load_dwordx4 v11, s[24:27], s65 offen offset:2048 lds
  buffer_load_dwordx4 v11, s[24:27], s65 offen offset:3072 lds
  s_add_u32 m0, s68, 86016
  s_add_u32 s65, s67, 1376256
  buffer_load_dwordx4 v13, s[28:31], s65 offen lds
  buffer_load_dwordx4 v13, s[28:31], s65 offen offset:1024 lds
  buffer_load_dwordx4 v13, s[28:31], s65 offen offset:2048 lds
  s_bitcmp1_b32 s58, 1
  s_cbranch_scc1 L_sj1
  s_add_u32 m0, s99, 0
  s_add_u32 s65, s98, 0
  buffer_load_dwordx4 v16, s[36:39], s65 offen lds
  buffer_load_dwordx4 v17, s[36:39], s65 offen offset:1024 lds
  buffer_load_dwordx4 v18, s[36:39], s65 offen offset:2048 lds
  buffer_load_dwordx4 v19, s[36:39], s65 offen offset:3072 lds
  s_branch L_sj2
L_sj1:
  s_add_u32 m0, s99, 4096
  s_add_u32 s65, s98, 0
  buffer_load_dwordx4 v20, s[36:39], s65 offen lds
  buffer_load_dwordx4 v21, s[36:39], s65 offen offset:1024 lds
  buffer_load_dwordx4 v22, s[36:39], s65 offen offset:2048 lds
L_sj2:
  s_waitcnt vmcnt(7)
  s_barrier
  s_add_u32 m0, s73, 131072
  s_add_u32 s65, s72, 262144
  buffer_load_dwordx4 v14, s[32:35], s65 offen lds
  s_add_u32 m0, s73, 135168
  s_add_u32 s65, s72, 294912
  buffer_load_dwordx4 v14, s[32:35], s65 offen lds
  s_add_u32 m0, s73, 139264
  s_add_u32 s65, s72, 327680
  buffer_load_dwordx4 v14, s[32:35], s65 offen lds
  s_add_u32 m0, s73, 143360
  s_add_u32 s65, s72, 360448
  buffer_load_dwordx4 v14, s[32:35], s65 offen lds
  s_waitcnt vmcnt(4)
  s_waitcnt vmcnt(4)
  s_barrier
  s_add_u32 m0, s73, 98304
  s_add_u32 s65, s72, 0
  buffer_load_dwordx4 v14, s[32:35], s65 offen lds
  s_add_u32 m0, s73, 102400
  s_add_u32 s65, s72, 32768
  buffer_load_dwordx4 v14, s[32:35], s65 offen lds
  s_add_u32 m0, s73, 106496
  s_add_u32 s65, s72, 65536
  buffer_load_dwordx4 v14, s[32:35], s65 offen lds
  s_add_u32 m0, s73, 110592
  s_add_u32 s65, s72, 98304
  buffer_load_dwordx4 v14, s[32:35], s65 offen lds
  s_barrier
  s_add_u32 m0, s73, 114688
  s_add_u32 s65, s72, 131072
  buffer_load_dwordx4 v14, s[32:35], s65 offen lds
  s_add_u32 m0, s73, 118784
  s_add_u32 s65, s72, 163840
  buffer_load_dwordx4 v14, s[32:35], s65 offen lds
  s_add_u32 m0, s73, 122880
  s_add_u32 s65, s72, 196608
  buffer_load_dwordx4 v14, s[32:35], s65 offen lds
  s_add_u32 m0, s73, 126976
  s_add_u32 s65, s72, 229376
  buffer_load_dwordx4 v14, s[32:35], s65 offen lds
  s_add_u32 m0, s73, 147456
  s_add_u32 s65, s72, 393216
  buffer_load_dwordx4 v14, s[32:35], s65 offen lds
  s_add_u32 m0, s73, 151552
  s_add_u32 s65, s72, 425984
  buffer_load_dwordx4 v14, s[32:35], s65 offen lds
  s_add_u32 m0, s73, 155648
  s_add_u32 s65, s72, 458752
  buffer_load_dwordx4 v14, s[32:35], s65 offen lds
  s_add_u32 m0, s73, 159744
  s_add_u32 s65, s72, 491520
  buffer_load_dwordx4 v14, s[32:35], s65 offen lds
  buffer_load_dword v41, v40, s[40:43], 0 offen
  s_barrier
  v_mov_b32 v4, 0
  buffer_load_dword v45, v4, s[52:55], 0 offen sc1
  s_add_u32 m0, s71, 0
  s_add_u32 s65, s70, 0
  buffer_load_dwordx4 v16, s[36:39], s65 offen lds
  buffer_load_dwordx4 v17, s[36:39], s65 offen offset:1024 lds
  buffer_load_dwordx4 v18, s[36:39], s65 offen offset:2048 lds
  buffer_load_dwordx4 v19, s[36:39], s65 offen offset:3072 lds
  s_add_u32 m0, s71, 4096
  s_add_u32 s65, s70, 0
  buffer_load_dwordx4 v20, s[36:39], s65 offen lds
  buffer_load_dwordx4 v21, s[36:39], s65 offen offset:1024 lds
  buffer_load_dwordx4 v22, s[36:39], s65 offen offset:2048 lds
  s_add_u32 m0, s71, 28928
  s_add_u32 s65, s70, 229376
  buffer_load_dwordx4 v16, s[36:39], s65 offen lds
  buffer_load_dwordx4 v17, s[36:39], s65 offen offset:1024 lds
  buffer_load_dwordx4 v18, s[36:39], s65 offen offset:2048 lds
  buffer_load_dwordx4 v19, s[36:39], s65 offen offset:3072 lds
  s_add_u32 m0, s71, 33024
  s_add_u32 s65, s70, 229376
  buffer_load_dwordx4 v20, s[36:39], s65 offen lds
  buffer_load_dwordx4 v21, s[36:39], s65 offen offset:1024 lds
  buffer_load_dwordx4 v22, s[36:39], s65 offen offset:2048 lds
  s_waitcnt vmcnt(14)
  v_readfirstlane_b32 s59, v45
  s_mov_b32 s66, 0x10000
  v_mov_b32 v4, 0
  s_nop 2
  s_cmp_lg_u32 s59, 0
  s_cbranch_scc1 L_f1l_nok
L_f1l_n:
  buffer_load_dword v5, v4, s[52:55], 0 offen sc1
  s_waitcnt vmcnt(0)
  v_readfirstlane_b32 s59, v5
  s_nop 3
  s_cmp_lg_u32 s59, 0
  s_cbranch_scc1 L_f1l_nok
  s_sub_u32 s66, s66, 1
  s_cbranch_scc0 L_f1l_n
L_f1l_nok:
  s_lshl_b32 s64, s2, 7
  s_add_u32 s64, s64, 524288
  v_mul_u32_u24 v46, 12, v1
  v_add_u32 v46, s64, v46
  v_mov_b32 v47, s59
  s_barrier
  s_cmp_lg_u32 s58, 0
  s_cbranch_scc1 L_f1_lj
  s_mov_b64 exec, 3
  buffer_store_dword v47, v46, s[48:51], 0 offen offset:0 sc1
  s_mov_b64 exec, -1
L_f1_lj:
  s_add_u32 m0, s71, 57856
  s_add_u32 s65, s70, 458752
  buffer_load_dwordx4 v16, s[36:39], s65 offen lds
  buffer_load_dwordx4 v17, s[36:39], s65 offen offset:1024 lds
  buffer_load_dwordx4 v18, s[36:39], s65 offen offset:2048 lds
  buffer_load_dwordx4 v19, s[36:39], s65 offen offset:3072 lds
  s_add_u32 m0, s71, 61952
  s_add_u32 s65, s70, 458752
  buffer_load_dwordx4 v20, s[36:39], s65 offen lds
  buffer_load_dwordx4 v21, s[36:39], s65 offen offset:1024 lds
  buffer_load_dwordx4 v22, s[36:39], s65 offen offset:2048 lds
  s_barrier
  v_min_u32 v42, 786304, v40
  v_add_u32 v42, 1048576, v42
  buffer_load_dword v41, v42, s[40:43], 0 offen
  s_barrier
  s_cmp_lg_u32 s58, 0
  s_cbranch_scc1 L_f2_lj
  s_mov_b64 exec, 1
  buffer_store_dword v47, v46, s[48:51], 0 offen offset:4 sc1
  s_mov_b64 exec, -1
L_f2_lj:
  s_add_u32 m0, s71, 86784
  s_add_u32 s65, s70, 688128
  buffer_load_dwordx4 v16, s[36:39], s65 offen lds
  buffer_load_dwordx4 v17, s[36:39], s65 offen offset:1024 lds
  buffer_load_dwordx4 v18, s[36:39], s65 offen offset:2048 lds
  buffer_load_dwordx4 v19, s[36:39], s65 offen offset:3072 lds
  s_add_u32 m0, s71, 90880
  s_add_u32 s65, s70, 688128
  buffer_load_dwordx4 v20, s[36:39], s65 offen lds
  buffer_load_dwordx4 v21, s[36:39], s65 offen offset:1024 lds
  buffer_load_dwordx4 v22, s[36:39], s65 offen offset:2048 lds
  s_waitcnt vmcnt(22)
  s_waitcnt vmcnt(15)
  s_barrier
  s_barrier
  s_add_u32 m0, s71, 115712
  s_add_u32 s65, s70, 917504
  buffer_load_dwordx4 v16, s[36:39], s65 offen lds
  buffer_load_dwordx4 v17, s[36:39], s65 offen offset:1024 lds
  buffer_load_dwordx4 v18, s[36:39], s65 offen offset:2048 lds
  buffer_load_dwordx4 v19, s[36:39], s65 offen offset:3072 lds
  s_add_u32 m0, s71, 119808
  s_add_u32 s65, s70, 917504
  buffer_load_dwordx4 v20, s[36:39], s65 offen lds
  buffer_load_dwordx4 v21, s[36:39], s65 offen offset:1024 lds
  buffer_load_dwordx4 v22, s[36:39], s65 offen offset:2048 lds
  s_add_u32 m0, s73, 147456
  s_add_u32 s65, s72, 1572864
  buffer_load_dwordx4 v14, s[40:43], s65 offen lds
  s_add_u32 m0, s73, 151552
  s_add_u32 s65, s72, 1605632
  buffer_load_dwordx4 v14, s[40:43], s65 offen lds
  s_add_u32 m0, s73, 155648
  s_add_u32 s65, s72, 1638400
  buffer_load_dwordx4 v14, s[40:43], s65 offen lds
  s_waitcnt vmcnt(18)
  s_barrier
  s_add_u32 m0, s71, 0
  s_add_u32 s65, s70, 1146880
  buffer_load_dwordx4 v16, s[36:39], s65 offen lds
  buffer_load_dwordx4 v17, s[36:39], s65 offen offset:1024 lds
  buffer_load_dwordx4 v18, s[36:39], s65 offen offset:2048 lds
  buffer_load_dwordx4 v19, s[36:39], s65 offen offset:3072 lds
  s_add_u32 m0, s71, 4096
  s_add_u32 s65, s70, 1146880
  buffer_load_dwordx4 v20, s[36:39], s65 offen lds
  buffer_load_dwordx4 v21, s[36:39], s65 offen offset:1024 lds
  buffer_load_dwordx4 v22, s[36:39], s65 offen offset:2048 lds
  s_waitcnt vmcnt(17)
  s_barrier
  s_add_u32 m0, s71, 28928
  s_add_u32 s65, s70, 1376256
  buffer_load_dwordx4 v16, s[36:39], s65 offen lds
  buffer_load_dwordx4 v17, s[36:39], s65 offen offset:1024 lds
  buffer_load_dwordx4 v18, s[36:39], s65 offen offset:2048 lds
  buffer_load_dwordx4 v19, s[36:39], s65 offen offset:3072 lds
  s_add_u32 m0, s71, 33024
  s_add_u32 s65, s70, 1376256
  buffer_load_dwordx4 v20, s[36:39], s65 offen lds
  buffer_load_dwordx4 v21, s[36:39], s65 offen offset:1024 lds
  buffer_load_dwordx4 v22, s[36:39], s65 offen offset:2048 lds
  s_waitcnt vmcnt(17)
  s_barrier
  s_add_u32 m0, s71, 57856
  s_add_u32 s65, s70, 1605632
  buffer_load_dwordx4 v16, s[36:39], s65 offen lds
  buffer_load_dwordx4 v17, s[36:39], s65 offen offset:1024 lds
  buffer_load_dwordx4 v18, s[36:39], s65 offen offset:2048 lds
  buffer_load_dwordx4 v19, s[36:39], s65 offen offset:3072 lds
  s_add_u32 m0, s71, 61952
  s_add_u32 s65, s70, 1605632
  buffer_load_dwordx4 v20, s[36:39], s65 offen lds
  buffer_load_dwordx4 v21, s[36:39], s65 offen offset:1024 lds
  buffer_load_dwordx4 v22, s[36:39], s65 offen offset:2048 lds
  s_waitcnt vmcnt(14)
  s_barrier
  s_add_u32 m0, s73, 90112
  s_add_u32 s65, s72, 983040
  buffer_load_dwordx4 v14, s[40:43], s65 offen lds
  s_add_u32 m0, s73, 94208
  s_add_u32 s65, s72, 1015808
  buffer_load_dwordx4 v14, s[40:43], s65 offen lds
  s_add_u32 m0, s73, 98304
  s_add_u32 s65, s72, 1048576
  buffer_load_dwordx4 v14, s[40:43], s65 offen lds
  s_add_u32 m0, s73, 102400
  s_add_u32 s65, s72, 1081344
  buffer_load_dwordx4 v14, s[40:43], s65 offen lds
  s_add_u32 m0, s73, 106496
  s_add_u32 s65, s72, 1114112
  buffer_load_dwordx4 v14, s[40:43], s65 offen lds
  s_add_u32 m0, s73, 110592
  s_add_u32 s65, s72, 1146880
  buffer_load_dwordx4 v14, s[40:43], s65 offen lds
  s_waitcnt vmcnt(13)
  s_waitcnt vmcnt(6)
  s_barrier
  s_add_u32 m0, s73, 114688
  s_add_u32 s65, s72, 1179648
  buffer_load_dwordx4 v14, s[40:43], s65 offen lds
  s_add_u32 m0, s73, 118784
  s_add_u32 s65, s72, 1212416
  buffer_load_dwordx4 v14, s[40:43], s65 offen lds
  s_add_u32 m0, s73, 122880
  s_add_u32 s65, s72, 1376256
  buffer_load_dwordx4 v14, s[40:43], s65 offen lds
  s_add_u32 m0, s73, 126976
  s_add_u32 s65, s72, 1409024
  buffer_load_dwordx4 v14, s[40:43], s65 offen lds
  s_add_u32 m0, s73, 131072
  s_add_u32 s65, s72, 1441792
  buffer_load_dwordx4 v14, s[40:43], s65 offen lds
  s_add_u32 m0, s73, 135168
  s_add_u32 s65, s72, 1474560
  buffer_load_dwordx4 v14, s[40:43], s65 offen lds
  s_add_u32 m0, s73, 139264
  s_add_u32 s65, s72, 1507328
  buffer_load_dwordx4 v14, s[40:43], s65 offen lds
  s_add_u32 m0, s73, 143360
  s_add_u32 s65, s72, 1540096
  buffer_load_dwordx4 v14, s[40:43], s65 offen lds
  s_barrier
  s_add_u32 m0, s73, 0
  s_add_u32 s65, s72, 0
  buffer_load_dwordx4 v14, s[40:43], s65 offen lds
  s_add_u32 m0, s73, 4096
  s_add_u32 s65, s72, 32768
  buffer_load_dwordx4 v14, s[40:43], s65 offen lds
  s_add_u32 m0, s73, 8192
  s_add_u32 s65, s72, 65536
  buffer_load_dwordx4 v14, s[40:43], s65 offen lds
  s_add_u32 m0, s73, 12288
  s_add_u32 s65, s72, 98304
  buffer_load_dwordx4 v14, s[40:43], s65 offen lds
  s_add_u32 m0, s73, 16384
  s_add_u32 s65, s72, 131072
  buffer_load_dwordx4 v14, s[40:43], s65 offen lds
  s_add_u32 m0, s73, 20480
  s_add_u32 s65, s72, 163840
  buffer_load_dwordx4 v14, s[40:43], s65 offen lds
  s_add_u32 m0, s73, 24576
  s_add_u32 s65, s72, 196608
  buffer_load_dwordx4 v14, s[40:43], s65 offen lds
  s_barrier
  s_add_u32 m0, s73, 28672
  s_add_u32 s65, s72, 229376
  buffer_load_dwordx4 v14, s[40:43], s65 offen lds
  s_add_u32 m0, s73, 32768
  s_add_u32 s65, s72, 262144
  buffer_load_dwordx4 v14, s[40:43], s65 offen lds
  s_add_u32 m0, s73, 36864
  s_add_u32 s65, s72, 294912
  buffer_load_dwordx4 v14, s[40:43], s65 offen lds
  s_add_u32 m0, s73, 40960
  s_add_u32 s65, s72, 458752
  buffer_load_dwordx4 v14, s[40:43], s65 offen lds
  s_add_u32 m0, s73, 45056
  s_add_u32 s65, s72, 491520
  buffer_load_dwordx4 v14, s[40:43], s65 offen lds
  s_add_u32 m0, s73, 49152
  s_add_u32 s65, s72, 524288
  buffer_load_dwordx4 v14, s[40:43], s65 offen lds
  s_add_u32 m0, s73, 53248
  s_add_u32 s65, s72, 557056
  buffer_load_dwordx4 v14, s[40:43], s65 offen lds
  s_add_u32 m0, s73, 57344
  s_add_u32 s65, s72, 589824
  buffer_load_dwordx4 v14, s[40:43], s65 offen lds
  s_add_u32 m0, s73, 61440
  s_add_u32 s65, s72, 622592
  buffer_load_dwordx4 v14, s[40:43], s65 offen lds
  s_add_u32 m0, s73, 65536
  s_add_u32 s65, s72, 655360
  buffer_load_dwordx4 v14, s[40:43], s65 offen lds
  s_add_u32 m0, s73, 69632
  s_add_u32 s65, s72, 688128
  buffer_load_dwordx4 v14, s[40:43], s65 offen lds
  s_add_u32 m0, s73, 73728
  s_add_u32 s65, s72, 720896
  buffer_load_dwordx4 v14, s[40:43], s65 offen lds
  s_add_u32 m0, s73, 77824
  s_add_u32 s65, s72, 753664
  buffer_load_dwordx4 v14, s[40:43], s65 offen lds
  s_add_u32 m0, s73, 81920
  s_add_u32 s65, s72, 917504
  buffer_load_dwordx4 v14, s[40:43], s65 offen lds
  s_add_u32 m0, s73, 86016
  s_add_u32 s65, s72, 950272
  buffer_load_dwordx4 v14, s[40:43], s65 offen lds
  s_waitcnt vmcnt(0)
  s_barrier
  s_cmp_lg_u32 s58, 0
  s_cbranch_scc1 L_f3_lj
  s_mov_b64 exec, 1
  buffer_store_dword v47, v46, s[48:51], 0 offen offset:8 sc1
  s_mov_b64 exec, -1
L_f3_lj:
  s_add_u32 m0, s73, 159744
  s_add_u32 s65, s72, 1671168
  buffer_load_dwordx4 v14, s[40:43], s65 offen lds
  s_barrier
  s_add_u32 m0, s73, 0
  s_add_u32 s65, s72, 327680
  buffer_load_dwordx4 v14, s[40:43], s65 offen lds
  s_add_u32 m0, s73, 40960
  s_add_u32 s65, s72, 786432
  buffer_load_dwordx4 v14, s[40:43], s65 offen lds
  s_add_u32 m0, s73, 81920
  s_add_u32 s65, s72, 1245184
  buffer_load_dwordx4 v14, s[40:43], s65 offen lds
  s_add_u32 m0, s73, 122880
  s_add_u32 s65, s72, 1703936
  buffer_load_dwordx4 v14, s[40:43], s65 offen lds
  s_add_u32 m0, s73, 4096
  s_add_u32 s65, s72, 360448
  buffer_load_dwordx4 v14, s[40:43], s65 offen lds
  s_add_u32 m0, s73, 45056
  s_add_u32 s65, s72, 819200
  buffer_load_dwordx4 v14, s[40:43], s65 offen lds
  s_add_u32 m0, s73, 86016
  s_add_u32 s65, s72, 1277952
  buffer_load_dwordx4 v14, s[40:43], s65 offen lds
  s_add_u32 m0, s73, 126976
  s_add_u32 s65, s72, 1736704
  buffer_load_dwordx4 v14, s[40:43], s65 offen lds
  s_add_u32 m0, s73, 8192
  s_add_u32 s65, s72, 393216
  buffer_load_dwordx4 v14, s[40:43], s65 offen lds
  s_add_u32 m0, s73, 49152
  s_add_u32 s65, s72, 851968
  buffer_load_dwordx4 v14, s[40:43], s65 offen lds
  s_add_u32 m0, s73, 90112
  s_add_u32 s65, s72, 1310720
  buffer_load_dwordx4 v14, s[40:43], s65 offen lds
  s_add_u32 m0, s73, 131072
  s_add_u32 s65, s72, 1769472
  buffer_load_dwordx4 v14, s[40:43], s65 offen lds
  s_add_u32 m0, s73, 12288
  s_add_u32 s65, s72, 425984
  buffer_load_dwordx4 v14, s[40:43], s65 offen lds
  s_add_u32 m0, s73, 53248
  s_add_u32 s65, s72, 884736
  buffer_load_dwordx4 v14, s[40:43], s65 offen lds
  s_add_u32 m0, s73, 94208
  s_add_u32 s65, s72, 1343488
  buffer_load_dwordx4 v14, s[40:43], s65 offen lds
  s_add_u32 m0, s73, 135168
  s_add_u32 s65, s72, 1802240
  buffer_load_dwordx4 v14, s[40:43], s65 offen lds
  s_barrier
  s_waitcnt vmcnt(0)
  s_barrier
  s_barrier
  s_waitcnt vmcnt(0)
  s_endpgm
.section .rodata,"a"
.p2align 6
.amdhsa_kernel sequential_preLN__sliding_local_dilated__swiglu_ffn__prompt_kernel
  .amdhsa_next_free_vgpr 256
  .amdhsa_next_free_sgpr 102
  .amdhsa_accum_offset 192
  .amdhsa_group_segment_fixed_size 0
  .amdhsa_kernarg_size 80
  .amdhsa_user_sgpr_count 2
  .amdhsa_user_sgpr_kernarg_segment_ptr 1
  .amdhsa_system_sgpr_workgroup_id_x 1
.end_amdhsa_kernel
```
